```python
import torch

def _softmax(x, axis=-1):
    return torch.softmax(x, dim=axis)
def _gelu(x):
    return torch.nn.functional.gelu(x, approximate="tanh")
def _silu(x):
    return torch.nn.functional.silu(x)
def _sigmoid(x):
    return torch.sigmoid(x)
def _layernorm(x, axis=-1, eps=1e-5):
    m = x.mean(dim=axis, keepdim=True)
    v = x.var(dim=axis, keepdim=True, unbiased=False)
    return (x - m) / torch.sqrt(v + eps)
def _scatter_add(tgt, idx, src, axis=0):
    return tgt.clone().index_add_(axis, idx, src)
def _segment_sum(src, seg, n):
    out = torch.zeros((n,) + src.shape[1:], dtype=src.dtype)
    return out.index_add_(0, seg, src)
def _pad(x, pw):
    flat = tuple(v for pair in reversed(pw) for v in pair)
    return torch.nn.functional.pad(x, flat)

kernel_name = 'sequential_preLN__sliding_block_cached__glu_gated_reglu__decode'

def setup_inputs():

    _w = (lambda a: (lambda t: t.to(torch.bfloat16) if t.is_floating_point() else t)(torch.as_tensor(a)))
    def _A_setup():
        B, Sq, D = 1, 1, 576
        Hq, Hkv, Sk, Dh = 32, 16, 65536, 128
        assert Hq % Hkv == 0, (Hq, Hkv)
        return {
            "x": _w((lambda *s: torch.randn(*s, dtype=torch.bfloat16) * 0.05)(B, Sq, D)),
            "k_cache": _w((lambda *s: torch.randn(*s, dtype=torch.bfloat16) * 1.6)(B, Hkv, Sk, Dh)),
            "v_cache": _w((lambda *s: torch.randn(*s, dtype=torch.bfloat16) * 0.8)(B, Hkv, Sk, Dh)),
            "wq": _w((lambda *s: torch.randn(*s, dtype=torch.bfloat16) * 1.6)(D, Hq * Dh) * (D ** -0.5)),
            "wo": _w((lambda *s: torch.randn(*s, dtype=torch.bfloat16) * 0.8)(Hq * Dh, D) * ((Hq * Dh) ** -0.5)),
        }
    _A_in = _A_setup()

    def _B_setup():
        B, S, D, F = 1, 1, 576, 4608
        return {
            "x": _w((lambda *s: torch.randn(*s, dtype=torch.bfloat16) * 0.05)(B, S, D)),
            "W_gate": _w((lambda *s: torch.randn(*s, dtype=torch.bfloat16) * 0.4)(D, F) * (2.0 / D) ** 0.5),
            "W_up": _w((lambda *s: torch.randn(*s, dtype=torch.bfloat16) * 0.4)(D, F) * (2.0 / D) ** 0.5),
            "W_down": _w((lambda *s: torch.randn(*s, dtype=torch.bfloat16) * 0.4)(F, D) * (1.0 / F) ** 0.5),
        }
    _B_in = _B_setup()

    return {
        "A_x": _A_in["x"],
        "A_k_cache": _A_in["k_cache"],
        "A_v_cache": _A_in["v_cache"],
        "A_wq": _A_in["wq"],
        "A_wo": _A_in["wo"],
        "B_x": _B_in["x"],
        "B_W_gate": _B_in["W_gate"],
        "B_W_up": _B_in["W_up"],
        "B_W_down": _B_in["W_down"],
    }

def reference(A_x, A_k_cache, A_v_cache, A_wq, A_wo, B_x, B_W_gate, B_W_up, B_W_down):
    def _A_ref(x, k_cache, v_cache, wq, wo):
        B, Sq, D = x.shape
        Hq, Dh = 32, 128
        Hkv, Sk = k_cache.shape[1], k_cache.shape[2]
        W = min(4096, max(256, Sk // 4))
        rep = Hq // Hkv
        q = (lambda x, *d: x.permute(*d))((x @ wq).reshape(B, Sq, Hq, Dh), 0, 2, 1, 3)
        k = (lambda x, n, axis: torch.repeat_interleave(x, n, dim=axis))(k_cache[:, :, Sk - W:, :], rep, axis=1)
        v = (lambda x, n, axis: torch.repeat_interleave(x, n, dim=axis))(v_cache[:, :, Sk - W:, :], rep, axis=1)
        scores = torch.einsum("bhqd,bhkd->bhqk", q, k) * (Dh ** -0.5)
        p = _softmax(scores, axis=-1)
        o = torch.einsum("bhqk,bhkd->bhqd", p, v)
        return (lambda x, *d: x.permute(*d))(o, 0, 2, 1, 3).reshape(B, Sq, Hq * Dh) @ wo

    def _B_ref(x, W_gate, W_up, W_down):
        gate = torch.einsum("bsd,df->bsf", x, W_gate)
        up = torch.einsum("bsd,df->bsf", x, W_up)
        gate = gate * (lambda x, dt: x.to(dt))(gate > 0, gate.dtype)
        h = gate * up
        return torch.einsum("bsf,fd->bsd", h, W_down)

    x = A_x
    h = x + _A_ref(_layernorm(x, axis=-1), A_k_cache, A_v_cache, A_wq, A_wo)
    h2 = h + _B_ref(_layernorm(h, axis=-1), B_W_gate, B_W_up, B_W_down)
    return h2
```

```asm
; @launch grid=(256,1,1) block=(576,1,1) lds=123904
.amdgcn_target "amdgcn-amd-amdhsa--gfx950"
.text
.globl sequential_preLN__sliding_block_cached__glu_gated_reglu__decode_kernel
.p2align 8
.type sequential_preLN__sliding_block_cached__glu_gated_reglu__decode_kernel,@function
sequential_preLN__sliding_block_cached__glu_gated_reglu__decode_kernel:
L_start:
    s_cmp_ge_u32 s2, 256
    s_cbranch_scc1 L_end
    s_load_dwordx16 s[4:19], s[0:1], 0
    s_load_dwordx8 s[20:27], s[0:1], 64
    s_getpc_b64 s[64:65]
L_pfbase:
    s_lshr_b32 s66, s2, 3
    s_lshl_b32 s66, s66, 9
    v_lshlrev_b32 v6, 7, v0
    v_add_u32 v6, s66, v6
    v_min_u32 v6, L_end-L_pfbase, v6
    v_cmp_gt_u32 vcc, 4, v0
    s_and_saveexec_b64 s[66:67], vcc
    s_cbranch_execz L_pfskip
    global_load_dword v124, v6, s[64:65]
L_pfskip:
    s_mov_b64 exec, s[66:67]
    v_and_b32 v1, 63, v0
    v_lshrrev_b32 v6, 6, v0
    s_nop 0
    v_readfirstlane_b32 s30, v6
    s_and_b32 s28, s2, 7
    s_lshl_b32 s28, s28, 1
    s_lshr_b32 s33, s2, 7
    s_or_b32 s28, s28, s33
    s_lshr_b32 s29, s2, 3
    s_and_b32 s29, s29, 15
    v_and_b32 v2, 15, v1
    v_lshrrev_b32 v3, 4, v1
    v_lshlrev_b32 v8, 4, v1
    s_lshl_b32 s33, s28, 24
    s_lshl_b32 s64, s29, 16
    s_add_u32 s33, s33, s64
    s_add_u32 s33, s33, 15728640
    s_and_b32 s64, s30, 3
    s_lshl_b32 s64, s64, 14
    s_add_u32 s33, s33, s64
    s_movk_i32 s70, 0x1000
    s_movk_i32 s71, 0x2000
    s_movk_i32 s72, 0x3000
    v_bfe_u32 v13, v1, 2, 2
    v_lshlrev_b32 v13, 8, v13
    v_lshlrev_b32 v12, 6, v3
    v_add_u32 v13, v13, v12
    v_and_b32 v12, 3, v1
    v_lshlrev_b32 v12, 4, v12
    v_add_u32 v13, v13, v12
    v_lshlrev_b32 v11, 13, v3
    v_lshlrev_b32 v12, 4, v2
    v_add_u32 v11, v11, v12
    s_and_b32 s34, s29, 1
    s_lshl_b32 s35, s28, 1
    s_add_u32 s35, s35, s34
    s_lshl_b32 s35, s35, 8
    s_lshr_b32 s34, s29, 1
    s_mul_i32 s34, s34, 72
    v_add_u32 v9, s34, v1
    v_lshlrev_b32 v9, 1, v9
    s_lshl_b32 s34, s34, 13
    s_add_u32 s35, s35, s34
    s_movk_i32 s38, 1152
    s_mov_b32 s39, 0x20000
    s_mov_b32 s50, 4718592
    s_mov_b32 s51, 0x20000
    s_movk_i32 s42, 0x4000
    s_mov_b32 s43, 0x20000
    s_movk_i32 s46, 0x4000
    s_mov_b32 s47, 0x20000
    s_waitcnt lgkmcnt(0)
    s_mov_b32 s36, s4
    s_mov_b32 s37, s5
    s_mov_b32 s48, s10
    s_mov_b32 s49, s11
    s_add_u32 s40, s6, s33
    s_addc_u32 s41, s7, 0
    s_add_u32 s44, s8, s33
    s_addc_u32 s45, s9, 0
    s_cmp_eq_u32 s30, 8
    s_cbranch_scc1 L_qfirst
    s_cmp_lt_u32 s30, 4
    s_cbranch_scc1 L_vfirst
    s_setprio 2
    s_barrier
    buffer_load_dwordx4 v[32:35], v13, s[40:43], 0 offen offset:0 nt
    buffer_load_dwordx4 v[36:39], v13, s[40:43], 0 offen offset:1024 nt
    buffer_load_dwordx4 v[40:43], v13, s[40:43], 0 offen offset:2048 nt
    buffer_load_dwordx4 v[44:47], v13, s[40:43], 0 offen offset:3072 nt
    buffer_load_dwordx4 v[48:51], v13, s[40:43], s70 offen offset:0 nt
    buffer_load_dwordx4 v[52:55], v13, s[40:43], s70 offen offset:1024 nt
    buffer_load_dwordx4 v[56:59], v13, s[40:43], s70 offen offset:2048 nt
    buffer_load_dwordx4 v[60:63], v13, s[40:43], s70 offen offset:3072 nt
    buffer_load_dwordx4 v[64:67], v13, s[40:43], s71 offen offset:0 nt
    buffer_load_dwordx4 v[68:71], v13, s[40:43], s71 offen offset:1024 nt
    buffer_load_dwordx4 v[72:75], v13, s[40:43], s71 offen offset:2048 nt
    buffer_load_dwordx4 v[76:79], v13, s[40:43], s71 offen offset:3072 nt
    buffer_load_dwordx4 v[80:83], v13, s[40:43], s72 offen offset:0 nt
    buffer_load_dwordx4 v[84:87], v13, s[40:43], s72 offen offset:1024 nt
    buffer_load_dwordx4 v[88:91], v13, s[40:43], s72 offen offset:2048 nt
    buffer_load_dwordx4 v[92:95], v13, s[40:43], s72 offen offset:3072 nt
    s_load_dword s31, s[26:27], 0
    s_mov_b32 s52, s12
    s_mov_b32 s53, s13
    s_mov_b32 s54, 4718592
    s_mov_b32 s55, 0x20000
    s_mov_b32 s76, s16
    s_mov_b32 s77, s17
    s_mov_b32 s78, 5308416
    s_mov_b32 s79, 0x20000
    s_mov_b32 s80, s18
    s_mov_b32 s81, s19
    s_mov_b32 s82, 5308416
    s_mov_b32 s83, 0x20000
    s_mov_b32 s84, s20
    s_mov_b32 s85, s21
    s_mov_b32 s86, 5308416
    s_mov_b32 s87, 0x20000
    s_barrier
    s_branch L_kmain
L_vfirst:
    s_barrier
    s_load_dword s31, s[26:27], 0
    s_mov_b32 s52, s12
    s_mov_b32 s53, s13
    s_mov_b32 s54, 4718592
    s_mov_b32 s55, 0x20000
    s_mov_b32 s76, s16
    s_mov_b32 s77, s17
    s_mov_b32 s78, 5308416
    s_mov_b32 s79, 0x20000
    s_mov_b32 s80, s18
    s_mov_b32 s81, s19
    s_mov_b32 s82, 5308416
    s_mov_b32 s83, 0x20000
    s_mov_b32 s84, s20
    s_mov_b32 s85, s21
    s_mov_b32 s86, 5308416
    s_mov_b32 s87, 0x20000
    s_branch L_vwave
L_qfirst:
    s_setprio 3
    buffer_load_dwordx4 v[24:27], v8, s[36:39], 0 offen
    buffer_load_dwordx4 v[28:31], v8, s[36:39], 0 offen offset:1024
    buffer_load_ushort v14, v9, s[36:39], 0 offen
    buffer_load_ushort v15, v9, s[36:39], 0 offen offset:128
    buffer_load_dwordx4 v[32:35], v11, s[48:51], s35 offen nt
    s_add_u32 s35, s35, 0x8000
    buffer_load_dwordx4 v[36:39], v11, s[48:51], s35 offen nt
    s_add_u32 s35, s35, 0x8000
    buffer_load_dwordx4 v[40:43], v11, s[48:51], s35 offen nt
    s_add_u32 s35, s35, 0x8000
    buffer_load_dwordx4 v[44:47], v11, s[48:51], s35 offen nt
    s_add_u32 s35, s35, 0x8000
    buffer_load_dwordx4 v[48:51], v11, s[48:51], s35 offen nt
    s_add_u32 s35, s35, 0x8000
    buffer_load_dwordx4 v[52:55], v11, s[48:51], s35 offen nt
    s_add_u32 s35, s35, 0x8000
    buffer_load_dwordx4 v[56:59], v11, s[48:51], s35 offen nt
    s_add_u32 s35, s35, 0x8000
    buffer_load_dwordx4 v[60:63], v11, s[48:51], s35 offen nt
    s_add_u32 s35, s35, 0x8000
    buffer_load_dwordx4 v[64:67], v11, s[48:51], s35 offen nt
    s_add_u32 s35, s35, 0x8000
    buffer_load_dwordx4 v[68:71], v11, s[48:51], s35 offen nt
    s_add_u32 s35, s35, 0x8000
    buffer_load_dwordx4 v[72:75], v11, s[48:51], s35 offen nt
    s_add_u32 s35, s35, 0x8000
    buffer_load_dwordx4 v[76:79], v11, s[48:51], s35 offen nt
    s_add_u32 s35, s35, 0x8000
    buffer_load_dwordx4 v[80:83], v11, s[48:51], s35 offen nt
    s_add_u32 s35, s35, 0x8000
    buffer_load_dwordx4 v[84:87], v11, s[48:51], s35 offen nt
    s_add_u32 s35, s35, 0x8000
    buffer_load_dwordx4 v[88:91], v11, s[48:51], s35 offen nt
    s_add_u32 s35, s35, 0x8000
    buffer_load_dwordx4 v[92:95], v11, s[48:51], s35 offen nt
    s_add_u32 s35, s35, 0x8000
    buffer_load_dwordx4 v[96:99], v11, s[48:51], s35 offen nt
    s_add_u32 s35, s35, 0x8000
    buffer_load_dwordx4 v[100:103], v11, s[48:51], s35 offen nt
    v_mov_b32 v6, 0
    v_mov_b32 v16, 0
    v_mov_b32 v17, 0
    v_mov_b32 v18, 0
    v_mov_b32 v19, 0
    ds_write_b128 v6, v[16:19] offset:256
    s_waitcnt lgkmcnt(0)
    s_barrier
    s_load_dword s31, s[26:27], 0
    s_mov_b32 s52, s12
    s_mov_b32 s53, s13
    s_mov_b32 s54, 4718592
    s_mov_b32 s55, 0x20000
    s_mov_b32 s76, s16
    s_mov_b32 s77, s17
    s_mov_b32 s78, 5308416
    s_mov_b32 s79, 0x20000
    s_mov_b32 s80, s18
    s_mov_b32 s81, s19
    s_mov_b32 s82, 5308416
    s_mov_b32 s83, 0x20000
    s_mov_b32 s84, s20
    s_mov_b32 s85, s21
    s_mov_b32 s86, 5308416
    s_mov_b32 s87, 0x20000
    v_and_b32 v6, 1, v1
    v_lshlrev_b32 v6, 4, v6
    v_mov_b32 v12, 0xffff
    v_lshlrev_b32 v12, v6, v12
    v_bfe_u32 v6, v1, 1, 2
    v_cmp_eq_u32 vcc, 0, v6
    s_nop 1
    v_cndmask_b32 v120, 0, v12, vcc
    v_cmp_eq_u32 vcc, 1, v6
    s_nop 1
    v_cndmask_b32 v121, 0, v12, vcc
    v_cmp_eq_u32 vcc, 2, v6
    s_nop 1
    v_cndmask_b32 v122, 0, v12, vcc
    v_cmp_eq_u32 vcc, 3, v6
    s_nop 1
    v_cndmask_b32 v123, 0, v12, vcc
    s_mov_b32 s56, 0x07060500
    s_mov_b32 s57, 0x07060501
    s_mov_b32 s58, 0x07060502
    s_mov_b32 s59, 0x07060503
    s_mov_b32 s62, 0x0c0c0400
    s_mov_b32 s63, 0x04000c0c
    s_waitcnt vmcnt(18)
    v_mov_b32 v104, 0
    v_mov_b32 v105, 0
    s_mov_b32 s64, 0x3f803f80
    v_dot2_f32_bf16 v104, v24, s64, v104
    v_dot2_f32_bf16 v105, v24, v24, v105
    v_dot2_f32_bf16 v104, v25, s64, v104
    v_dot2_f32_bf16 v105, v25, v25, v105
    v_dot2_f32_bf16 v104, v26, s64, v104
    v_dot2_f32_bf16 v105, v26, v26, v105
    v_dot2_f32_bf16 v104, v27, s64, v104
    v_dot2_f32_bf16 v105, v27, v27, v105
    v_dot2_f32_bf16 v104, v28, s64, v104
    v_dot2_f32_bf16 v105, v28, v28, v105
    v_dot2_f32_bf16 v104, v29, s64, v104
    v_dot2_f32_bf16 v105, v29, v29, v105
    v_dot2_f32_bf16 v104, v30, s64, v104
    v_dot2_f32_bf16 v105, v30, v30, v105
    v_dot2_f32_bf16 v104, v31, s64, v104
    v_dot2_f32_bf16 v105, v31, v31, v105
    s_nop 1
    v_add_f32_dpp v104, v104, v104 row_ror:8 row_mask:0xf bank_mask:0xf
    v_add_f32_dpp v105, v105, v105 row_ror:8 row_mask:0xf bank_mask:0xf
    s_nop 0
    v_add_f32_dpp v104, v104, v104 row_ror:4 row_mask:0xf bank_mask:0xf
    v_add_f32_dpp v105, v105, v105 row_ror:4 row_mask:0xf bank_mask:0xf
    s_nop 0
    v_add_f32_dpp v104, v104, v104 row_ror:2 row_mask:0xf bank_mask:0xf
    v_add_f32_dpp v105, v105, v105 row_ror:2 row_mask:0xf bank_mask:0xf
    s_nop 0
    v_add_f32_dpp v104, v104, v104 row_ror:1 row_mask:0xf bank_mask:0xf
    v_add_f32_dpp v105, v105, v105 row_ror:1 row_mask:0xf bank_mask:0xf
    s_nop 1
    v_permlane16_swap_b32 v104, v105
    v_add_f32 v104, v104, v105
    v_mov_b32 v105, v104
    s_nop 1
    v_permlane32_swap_b32 v104, v105
    v_add_f32 v104, v104, v105
    s_nop 0
    v_readlane_b32 s64, v104, 0
    v_readlane_b32 s65, v104, 16
    s_mov_b32 s68, 0x3ae38e39
    v_mov_b32 v104, s64
    v_mov_b32 v105, s65
    v_mul_f32 v104, s68, v104
    v_mul_f32 v105, s68, v105
    v_fma_f32 v105, -v104, v104, v105
    v_max_f32 v105, 0, v105
    v_cvt_pk_bf16_f32 v105, v105, v105
    v_and_b32 v105, 0xffff0000, v105
    v_cvt_pk_bf16_f32 v104, v104, v104
    v_and_b32 v104, 0xffff0000, v104
    v_add_f32 v105, 0x3727c5ac, v105
    v_cvt_pk_bf16_f32 v105, v105, v105
    v_and_b32 v105, 0xffff0000, v105
    v_sqrt_f32 v105, v105
    s_nop 0
    v_cvt_pk_bf16_f32 v105, v105, v105
    v_and_b32 v105, 0xffff0000, v105
    v_rcp_f32 v106, v105
    v_and_b32 v6, 3, v1
    v_mul_u32_u24 v6, 48, v6
    v_lshrrev_b32 v12, 2, v1
    v_lshlrev_b32 v12, 1, v12
    v_add_u32 v6, v6, v12
    v_lshlrev_b32 v14, 16, v14
    v_sub_f32 v14, v14, v104
    v_cvt_pk_bf16_f32 v14, v14, v14
    v_and_b32 v14, 0xffff0000, v14
    v_mul_f32 v107, v14, v106
    v_fma_f32 v108, -v107, v105, v14
    v_fma_f32 v107, v108, v106, v107
    v_cvt_pk_bf16_f32 v14, v107, v107
    v_lshlrev_b32 v15, 16, v15
    v_sub_f32 v15, v15, v104
    v_cvt_pk_bf16_f32 v15, v15, v15
    v_and_b32 v15, 0xffff0000, v15
    v_mul_f32 v107, v15, v106
    v_fma_f32 v108, -v107, v105, v15
    v_fma_f32 v107, v108, v106, v107
    v_cvt_pk_bf16_f32 v15, v107, v107
    ds_write_b16 v6, v14 offset:0
    s_mov_b64 exec, 0xff
    ds_write_b16 v6, v15 offset:32
    s_mov_b64 exec, -1
    v_mul_u32_u24 v6, 48, v3
    s_waitcnt lgkmcnt(0)
    ds_read_b128 v[24:27], v6 offset:0
    ds_read_b128 v[28:31], v6 offset:16
    ds_read_b32 v11, v6 offset:32
    s_waitcnt lgkmcnt(0)
    s_mul_i32 s31, s31, 0x19660d
    s_add_u32 s31, s31, 0x3c6ef35f
    v_mov_b32 v7, s31
    s_mov_b32 s64, 0x01000100
    s_mov_b32 s65, 0x03020302
    v_perm_b32 v10, v24, v24, s64
    v_and_b32 v104, v10, v120
    v_and_b32 v105, v10, v121
    v_and_b32 v106, v10, v122
    v_and_b32 v107, v10, v123
    v_perm_b32 v10, v24, v24, s65
    v_and_b32 v108, v10, v120
    v_and_b32 v109, v10, v121
    v_and_b32 v110, v10, v122
    v_and_b32 v111, v10, v123
    v_perm_b32 v10, v25, v25, s64
    v_and_b32 v112, v10, v120
    v_and_b32 v113, v10, v121
    v_and_b32 v114, v10, v122
    v_and_b32 v115, v10, v123
    v_perm_b32 v10, v25, v25, s65
    v_and_b32 v116, v10, v120
    v_and_b32 v117, v10, v121
    v_and_b32 v118, v10, v122
    v_and_b32 v119, v10, v123
    v_perm_b32 v10, v26, v26, s64
    v_and_b32 v128, v10, v120
    v_and_b32 v129, v10, v121
    v_and_b32 v130, v10, v122
    v_and_b32 v131, v10, v123
    v_perm_b32 v10, v26, v26, s65
    v_and_b32 v132, v10, v120
    v_and_b32 v133, v10, v121
    v_and_b32 v134, v10, v122
    v_and_b32 v135, v10, v123
    v_perm_b32 v10, v27, v27, s64
    v_and_b32 v136, v10, v120
    v_and_b32 v137, v10, v121
    v_and_b32 v138, v10, v122
    v_and_b32 v139, v10, v123
    v_perm_b32 v10, v27, v27, s65
    v_and_b32 v140, v10, v120
    v_and_b32 v141, v10, v121
    v_and_b32 v142, v10, v122
    v_and_b32 v143, v10, v123
    v_perm_b32 v10, v28, v28, s64
    v_and_b32 v144, v10, v120
    v_and_b32 v145, v10, v121
    v_and_b32 v146, v10, v122
    v_and_b32 v147, v10, v123
    v_perm_b32 v10, v28, v28, s65
    v_and_b32 v148, v10, v120
    v_and_b32 v149, v10, v121
    v_and_b32 v150, v10, v122
    v_and_b32 v151, v10, v123
    v_perm_b32 v10, v29, v29, s64
    v_and_b32 v152, v10, v120
    v_and_b32 v153, v10, v121
    v_and_b32 v154, v10, v122
    v_and_b32 v155, v10, v123
    v_perm_b32 v10, v29, v29, s65
    v_and_b32 v156, v10, v120
    v_and_b32 v157, v10, v121
    v_and_b32 v158, v10, v122
    v_and_b32 v159, v10, v123
    v_perm_b32 v10, v30, v30, s64
    v_and_b32 v160, v10, v120
    v_and_b32 v161, v10, v121
    v_and_b32 v162, v10, v122
    v_and_b32 v163, v10, v123
    v_perm_b32 v10, v30, v30, s65
    v_and_b32 v16, v10, v120
    v_and_b32 v17, v10, v121
    v_and_b32 v18, v10, v122
    v_and_b32 v19, v10, v123
    v_perm_b32 v10, v31, v31, s64
    v_and_b32 v20, v10, v120
    v_and_b32 v21, v10, v121
    v_and_b32 v22, v10, v122
    v_and_b32 v23, v10, v123
    v_perm_b32 v10, v31, v31, s65
    v_and_b32 v12, v10, v120
    v_and_b32 v13, v10, v121
    v_and_b32 v14, v10, v122
    v_and_b32 v15, v10, v123
    s_waitcnt vmcnt(17)
    v_mfma_f32_16x16x32_bf16 v[164:167], v[104:107], v[32:35], 0
    s_waitcnt vmcnt(16)
    v_mfma_f32_16x16x32_bf16 v[164:167], v[108:111], v[36:39], v[164:167]
    v_perm_b32 v10, v11, v11, s64
    v_and_b32 v104, v10, v120
    v_and_b32 v105, v10, v121
    v_and_b32 v106, v10, v122
    v_and_b32 v107, v10, v123
    v_perm_b32 v10, v11, v11, s65
    v_and_b32 v108, v10, v120
    v_and_b32 v109, v10, v121
    v_and_b32 v110, v10, v122
    v_and_b32 v111, v10, v123
    s_waitcnt vmcnt(15)
    v_mfma_f32_16x16x32_bf16 v[164:167], v[112:115], v[40:43], v[164:167]
    s_waitcnt vmcnt(14)
    v_mfma_f32_16x16x32_bf16 v[164:167], v[116:119], v[44:47], v[164:167]
    s_waitcnt vmcnt(13)
    v_mfma_f32_16x16x32_bf16 v[164:167], v[128:131], v[48:51], v[164:167]
    s_waitcnt vmcnt(12)
    v_mfma_f32_16x16x32_bf16 v[164:167], v[132:135], v[52:55], v[164:167]
    s_waitcnt vmcnt(11)
    v_mfma_f32_16x16x32_bf16 v[164:167], v[136:139], v[56:59], v[164:167]
    s_waitcnt vmcnt(10)
    v_mfma_f32_16x16x32_bf16 v[164:167], v[140:143], v[60:63], v[164:167]
    s_waitcnt vmcnt(9)
    v_mfma_f32_16x16x32_bf16 v[164:167], v[144:147], v[64:67], v[164:167]
    s_waitcnt vmcnt(8)
    v_mfma_f32_16x16x32_bf16 v[164:167], v[148:151], v[68:71], v[164:167]
    s_waitcnt vmcnt(7)
    v_mfma_f32_16x16x32_bf16 v[164:167], v[152:155], v[72:75], v[164:167]
    s_waitcnt vmcnt(6)
    v_mfma_f32_16x16x32_bf16 v[164:167], v[156:159], v[76:79], v[164:167]
    s_waitcnt vmcnt(5)
    v_mfma_f32_16x16x32_bf16 v[164:167], v[160:163], v[80:83], v[164:167]
    s_waitcnt vmcnt(4)
    v_mfma_f32_16x16x32_bf16 v[164:167], v[16:19], v[84:87], v[164:167]
    s_waitcnt vmcnt(3)
    v_mfma_f32_16x16x32_bf16 v[164:167], v[20:23], v[88:91], v[164:167]
    s_waitcnt vmcnt(2)
    v_mfma_f32_16x16x32_bf16 v[164:167], v[12:15], v[92:95], v[164:167]
    s_waitcnt vmcnt(1)
    v_mfma_f32_16x16x32_bf16 v[164:167], v[104:107], v[96:99], v[164:167]
    s_waitcnt vmcnt(0)
    v_mfma_f32_16x16x32_bf16 v[164:167], v[108:111], v[100:103], v[164:167]
    s_lshl_b32 s64, s28, 13
    s_lshl_b32 s65, s29, 9
    s_add_u32 s65, s65, s64
    s_add_u32 s65, s65, 65536
    v_lshlrev_b32 v6, 5, v2
    v_lshlrev_b32 v12, 4, v3
    v_add_u32 v6, v6, v12
    v_add_u32 v6, s65, v6
    v_perm_b32 v164, v164, v7, s56
    v_perm_b32 v165, v165, v7, s57
    v_perm_b32 v166, v166, v7, s58
    v_perm_b32 v167, v167, v7, s59
    s_mov_b32 exec_lo, -1
    s_mov_b32 exec_hi, 0
    v_add_u32 v125, 1048576, v6
    global_store_dwordx4 v125, v[164:167], s[26:27]
    global_store_dwordx4 v6, v[164:167], s[26:27] sc1
    s_mov_b64 exec, -1
    s_barrier
    s_add_u32 s64, s64, 1114112
    v_add_u32 v6, s64, v8
    v_add_u32 v9, 4096, v6
    s_sleep 34
    s_mov_b32 s66, 0
    global_load_dwordx4 v[32:35], v6, s[26:27] offset:0 sc1
    global_load_dwordx4 v[36:39], v6, s[26:27] offset:1024 sc1
    global_load_dwordx4 v[40:43], v6, s[26:27] offset:2048 sc1
    global_load_dwordx4 v[44:47], v6, s[26:27] offset:3072 sc1
    global_load_dwordx4 v[48:51], v9, s[26:27] offset:0 sc1
    global_load_dwordx4 v[52:55], v9, s[26:27] offset:1024 sc1
    global_load_dwordx4 v[56:59], v9, s[26:27] offset:2048 sc1
    global_load_dwordx4 v[60:63], v9, s[26:27] offset:3072 sc1
    s_sleep 28
    global_load_dwordx4 v[64:67], v6, s[26:27] offset:0 sc1
    global_load_dwordx4 v[68:71], v6, s[26:27] offset:1024 sc1
    global_load_dwordx4 v[72:75], v6, s[26:27] offset:2048 sc1
    global_load_dwordx4 v[76:79], v6, s[26:27] offset:3072 sc1
    global_load_dwordx4 v[80:83], v9, s[26:27] offset:0 sc1
    global_load_dwordx4 v[84:87], v9, s[26:27] offset:1024 sc1
    global_load_dwordx4 v[88:91], v9, s[26:27] offset:2048 sc1
    global_load_dwordx4 v[92:95], v9, s[26:27] offset:3072 sc1
    s_waitcnt vmcnt(8)
    v_perm_b32 v100, v33, v32, s62
    v_perm_b32 v101, v35, v34, s63
    v_or_b32 v100, v100, v101
    v_cmp_ne_u32 vcc, v100, v7
    s_mov_b64 s[60:61], vcc
    v_perm_b32 v100, v37, v36, s62
    v_perm_b32 v101, v39, v38, s63
    v_or_b32 v100, v100, v101
    v_cmp_ne_u32 vcc, v100, v7
    s_or_b64 s[60:61], s[60:61], vcc
    v_perm_b32 v100, v41, v40, s62
    v_perm_b32 v101, v43, v42, s63
    v_or_b32 v100, v100, v101
    v_cmp_ne_u32 vcc, v100, v7
    s_or_b64 s[60:61], s[60:61], vcc
    v_perm_b32 v100, v45, v44, s62
    v_perm_b32 v101, v47, v46, s63
    v_or_b32 v100, v100, v101
    v_cmp_ne_u32 vcc, v100, v7
    s_or_b64 s[60:61], s[60:61], vcc
    v_perm_b32 v100, v49, v48, s62
    v_perm_b32 v101, v51, v50, s63
    v_or_b32 v100, v100, v101
    v_cmp_ne_u32 vcc, v100, v7
    s_or_b64 s[60:61], s[60:61], vcc
    v_perm_b32 v100, v53, v52, s62
    v_perm_b32 v101, v55, v54, s63
    v_or_b32 v100, v100, v101
    v_cmp_ne_u32 vcc, v100, v7
    s_or_b64 s[60:61], s[60:61], vcc
    v_perm_b32 v100, v57, v56, s62
    v_perm_b32 v101, v59, v58, s63
    v_or_b32 v100, v100, v101
    v_cmp_ne_u32 vcc, v100, v7
    s_or_b64 s[60:61], s[60:61], vcc
    v_perm_b32 v100, v61, v60, s62
    v_perm_b32 v101, v63, v62, s63
    v_or_b32 v100, v100, v101
    v_cmp_ne_u32 vcc, v100, v7
    s_or_b64 s[60:61], s[60:61], vcc
    s_mov_b64 vcc, s[60:61]
    s_cbranch_vccz L_h1ok
    global_load_dwordx4 v[128:131], v6, s[26:27] offset:0 sc1
    global_load_dwordx4 v[132:135], v6, s[26:27] offset:1024 sc1
    global_load_dwordx4 v[136:139], v6, s[26:27] offset:2048 sc1
    global_load_dwordx4 v[140:143], v6, s[26:27] offset:3072 sc1
    global_load_dwordx4 v[144:147], v9, s[26:27] offset:0 sc1
    global_load_dwordx4 v[148:151], v9, s[26:27] offset:1024 sc1
    global_load_dwordx4 v[152:155], v9, s[26:27] offset:2048 sc1
    global_load_dwordx4 v[156:159], v9, s[26:27] offset:3072 sc1
    s_waitcnt vmcnt(8)
    v_perm_b32 v100, v65, v64, s62
    v_perm_b32 v101, v67, v66, s63
    v_or_b32 v100, v100, v101
    v_cmp_ne_u32 vcc, v100, v7
    s_mov_b64 s[60:61], vcc
    v_perm_b32 v100, v69, v68, s62
    v_perm_b32 v101, v71, v70, s63
    v_or_b32 v100, v100, v101
    v_cmp_ne_u32 vcc, v100, v7
    s_or_b64 s[60:61], s[60:61], vcc
    v_perm_b32 v100, v73, v72, s62
    v_perm_b32 v101, v75, v74, s63
    v_or_b32 v100, v100, v101
    v_cmp_ne_u32 vcc, v100, v7
    s_or_b64 s[60:61], s[60:61], vcc
    v_perm_b32 v100, v77, v76, s62
    v_perm_b32 v101, v79, v78, s63
    v_or_b32 v100, v100, v101
    v_cmp_ne_u32 vcc, v100, v7
    s_or_b64 s[60:61], s[60:61], vcc
    v_perm_b32 v100, v81, v80, s62
    v_perm_b32 v101, v83, v82, s63
    v_or_b32 v100, v100, v101
    v_cmp_ne_u32 vcc, v100, v7
    s_or_b64 s[60:61], s[60:61], vcc
    v_perm_b32 v100, v85, v84, s62
    v_perm_b32 v101, v87, v86, s63
    v_or_b32 v100, v100, v101
    v_cmp_ne_u32 vcc, v100, v7
    s_or_b64 s[60:61], s[60:61], vcc
    v_perm_b32 v100, v89, v88, s62
    v_perm_b32 v101, v91, v90, s63
    v_or_b32 v100, v100, v101
    v_cmp_ne_u32 vcc, v100, v7
    s_or_b64 s[60:61], s[60:61], vcc
    v_perm_b32 v100, v93, v92, s62
    v_perm_b32 v101, v95, v94, s63
    v_or_b32 v100, v100, v101
    v_cmp_ne_u32 vcc, v100, v7
    s_or_b64 s[60:61], s[60:61], vcc
    s_mov_b64 vcc, s[60:61]
    s_cbranch_vccnz L_h1c
    v_mov_b32 v32, v64
    v_mov_b32 v33, v65
    v_mov_b32 v34, v66
    v_mov_b32 v35, v67
    v_mov_b32 v36, v68
    v_mov_b32 v37, v69
    v_mov_b32 v38, v70
    v_mov_b32 v39, v71
    v_mov_b32 v40, v72
    v_mov_b32 v41, v73
    v_mov_b32 v42, v74
    v_mov_b32 v43, v75
    v_mov_b32 v44, v76
    v_mov_b32 v45, v77
    v_mov_b32 v46, v78
    v_mov_b32 v47, v79
    v_mov_b32 v48, v80
    v_mov_b32 v49, v81
    v_mov_b32 v50, v82
    v_mov_b32 v51, v83
    v_mov_b32 v52, v84
    v_mov_b32 v53, v85
    v_mov_b32 v54, v86
    v_mov_b32 v55, v87
    v_mov_b32 v56, v88
    v_mov_b32 v57, v89
    v_mov_b32 v58, v90
    v_mov_b32 v59, v91
    v_mov_b32 v60, v92
    v_mov_b32 v61, v93
    v_mov_b32 v62, v94
    v_mov_b32 v63, v95
    s_branch L_h1ok
L_h1c:
    s_waitcnt vmcnt(0)
    v_mov_b32 v32, v128
    v_mov_b32 v33, v129
    v_mov_b32 v34, v130
    v_mov_b32 v35, v131
    v_mov_b32 v36, v132
    v_mov_b32 v37, v133
    v_mov_b32 v38, v134
    v_mov_b32 v39, v135
    v_mov_b32 v40, v136
    v_mov_b32 v41, v137
    v_mov_b32 v42, v138
    v_mov_b32 v43, v139
    v_mov_b32 v44, v140
    v_mov_b32 v45, v141
    v_mov_b32 v46, v142
    v_mov_b32 v47, v143
    v_mov_b32 v48, v144
    v_mov_b32 v49, v145
    v_mov_b32 v50, v146
    v_mov_b32 v51, v147
    v_mov_b32 v52, v148
    v_mov_b32 v53, v149
    v_mov_b32 v54, v150
    v_mov_b32 v55, v151
    v_mov_b32 v56, v152
    v_mov_b32 v57, v153
    v_mov_b32 v58, v154
    v_mov_b32 v59, v155
    v_mov_b32 v60, v156
    v_mov_b32 v61, v157
    v_mov_b32 v62, v158
    v_mov_b32 v63, v159
L_h1loop:
    s_waitcnt vmcnt(0)
    v_perm_b32 v100, v33, v32, s62
    v_perm_b32 v101, v35, v34, s63
    v_or_b32 v100, v100, v101
    v_cmp_ne_u32 vcc, v100, v7
    s_mov_b64 s[60:61], vcc
    v_perm_b32 v100, v37, v36, s62
    v_perm_b32 v101, v39, v38, s63
    v_or_b32 v100, v100, v101
    v_cmp_ne_u32 vcc, v100, v7
    s_or_b64 s[60:61], s[60:61], vcc
    v_perm_b32 v100, v41, v40, s62
    v_perm_b32 v101, v43, v42, s63
    v_or_b32 v100, v100, v101
    v_cmp_ne_u32 vcc, v100, v7
    s_or_b64 s[60:61], s[60:61], vcc
    v_perm_b32 v100, v45, v44, s62
    v_perm_b32 v101, v47, v46, s63
    v_or_b32 v100, v100, v101
    v_cmp_ne_u32 vcc, v100, v7
    s_or_b64 s[60:61], s[60:61], vcc
    v_perm_b32 v100, v49, v48, s62
    v_perm_b32 v101, v51, v50, s63
    v_or_b32 v100, v100, v101
    v_cmp_ne_u32 vcc, v100, v7
    s_or_b64 s[60:61], s[60:61], vcc
    v_perm_b32 v100, v53, v52, s62
    v_perm_b32 v101, v55, v54, s63
    v_or_b32 v100, v100, v101
    v_cmp_ne_u32 vcc, v100, v7
    s_or_b64 s[60:61], s[60:61], vcc
    v_perm_b32 v100, v57, v56, s62
    v_perm_b32 v101, v59, v58, s63
    v_or_b32 v100, v100, v101
    v_cmp_ne_u32 vcc, v100, v7
    s_or_b64 s[60:61], s[60:61], vcc
    v_perm_b32 v100, v61, v60, s62
    v_perm_b32 v101, v63, v62, s63
    v_or_b32 v100, v100, v101
    v_cmp_ne_u32 vcc, v100, v7
    s_or_b64 s[60:61], s[60:61], vcc
    s_mov_b64 vcc, s[60:61]
    s_cbranch_vccz L_h1ok
    s_add_u32 s66, s66, 1
    s_cmp_gt_u32 s66, 20000
    s_cbranch_scc1 L_h1ok
    s_cmp_eq_u32 s66, 2
    s_cbranch_scc0 L_h1keep
    v_subrev_u32 v6, 1048576, v6
    v_subrev_u32 v9, 1048576, v9
L_h1keep:
    s_sleep 2
    global_load_dwordx4 v[32:35], v6, s[26:27] offset:0 sc1
    global_load_dwordx4 v[36:39], v6, s[26:27] offset:1024 sc1
    global_load_dwordx4 v[40:43], v6, s[26:27] offset:2048 sc1
    global_load_dwordx4 v[44:47], v6, s[26:27] offset:3072 sc1
    global_load_dwordx4 v[48:51], v9, s[26:27] offset:0 sc1
    global_load_dwordx4 v[52:55], v9, s[26:27] offset:1024 sc1
    global_load_dwordx4 v[56:59], v9, s[26:27] offset:2048 sc1
    global_load_dwordx4 v[60:63], v9, s[26:27] offset:3072 sc1
    s_branch L_h1loop
L_h1ok:
    v_and_b32 v32, 0xffffff00, v32
    v_and_b32 v33, 0xffffff00, v33
    v_and_b32 v34, 0xffffff00, v34
    v_and_b32 v35, 0xffffff00, v35
    v_and_b32 v36, 0xffffff00, v36
    v_and_b32 v37, 0xffffff00, v37
    v_and_b32 v38, 0xffffff00, v38
    v_and_b32 v39, 0xffffff00, v39
    v_and_b32 v40, 0xffffff00, v40
    v_and_b32 v41, 0xffffff00, v41
    v_and_b32 v42, 0xffffff00, v42
    v_and_b32 v43, 0xffffff00, v43
    v_and_b32 v44, 0xffffff00, v44
    v_and_b32 v45, 0xffffff00, v45
    v_and_b32 v46, 0xffffff00, v46
    v_and_b32 v47, 0xffffff00, v47
    v_and_b32 v48, 0xffffff00, v48
    v_and_b32 v49, 0xffffff00, v49
    v_and_b32 v50, 0xffffff00, v50
    v_and_b32 v51, 0xffffff00, v51
    v_and_b32 v52, 0xffffff00, v52
    v_and_b32 v53, 0xffffff00, v53
    v_and_b32 v54, 0xffffff00, v54
    v_and_b32 v55, 0xffffff00, v55
    v_and_b32 v56, 0xffffff00, v56
    v_and_b32 v57, 0xffffff00, v57
    v_and_b32 v58, 0xffffff00, v58
    v_and_b32 v59, 0xffffff00, v59
    v_and_b32 v60, 0xffffff00, v60
    v_and_b32 v61, 0xffffff00, v61
    v_and_b32 v62, 0xffffff00, v62
    v_and_b32 v63, 0xffffff00, v63
    v_add_f32 v32, v32, v36
    v_add_f32 v33, v33, v37
    v_add_f32 v34, v34, v38
    v_add_f32 v35, v35, v39
    v_add_f32 v40, v40, v44
    v_add_f32 v41, v41, v45
    v_add_f32 v42, v42, v46
    v_add_f32 v43, v43, v47
    v_add_f32 v48, v48, v52
    v_add_f32 v49, v49, v53
    v_add_f32 v50, v50, v54
    v_add_f32 v51, v51, v55
    v_add_f32 v56, v56, v60
    v_add_f32 v57, v57, v61
    v_add_f32 v58, v58, v62
    v_add_f32 v59, v59, v63
    v_add_f32 v32, v32, v40
    v_add_f32 v33, v33, v41
    v_add_f32 v34, v34, v42
    v_add_f32 v35, v35, v43
    v_add_f32 v48, v48, v56
    v_add_f32 v49, v49, v57
    v_add_f32 v50, v50, v58
    v_add_f32 v51, v51, v59
    v_add_f32 v32, v32, v48
    v_add_f32 v33, v33, v49
    v_add_f32 v34, v34, v50
    v_add_f32 v35, v35, v51
    v_cvt_pk_bf16_f32 v32, v32, v33
    v_cvt_pk_bf16_f32 v33, v34, v35
    v_lshlrev_b32 v6, 3, v1
    ds_write_b64 v6, v[32:33] offset:512
    v_mov_b32 v6, 0
    v_mov_b32 v12, 1
    s_waitcnt lgkmcnt(0)
    ds_write_b32 v6, v12 offset:256
    s_waitcnt lgkmcnt(0)
    s_waitcnt vmcnt(0)
    s_barrier
    v_mov_b32 v6, 0
    ds_read_b128 v[32:35], v6 offset:1024
    ds_read_b128 v[36:39], v6 offset:1040
    ds_read_b128 v[40:43], v6 offset:1056
    ds_read_b128 v[44:47], v6 offset:1072
    s_waitcnt lgkmcnt(0)
    v_max3_f32 v16, v32, v33, v34
    v_max_f32 v16, v16, v35
    v_sub_f32 v32, v32, v16
    v_sub_f32 v33, v33, v16
    v_sub_f32 v34, v34, v16
    v_sub_f32 v35, v35, v16
    v_mul_f32 v32, 0x3fb8aa3b, v32
    v_mul_f32 v33, 0x3fb8aa3b, v33
    v_mul_f32 v34, 0x3fb8aa3b, v34
    v_mul_f32 v35, 0x3fb8aa3b, v35
    v_exp_f32 v32, v32
    v_exp_f32 v33, v33
    v_exp_f32 v34, v34
    v_exp_f32 v35, v35
    v_mul_f32 v17, v32, v40
    v_fma_f32 v17, v33, v41, v17
    v_fma_f32 v17, v34, v42, v17
    v_fma_f32 v17, v35, v43, v17
    v_max3_f32 v18, v36, v37, v38
    v_max_f32 v18, v18, v39
    v_sub_f32 v36, v36, v18
    v_sub_f32 v37, v37, v18
    v_sub_f32 v38, v38, v18
    v_sub_f32 v39, v39, v18
    v_mul_f32 v36, 0x3fb8aa3b, v36
    v_mul_f32 v37, 0x3fb8aa3b, v37
    v_mul_f32 v38, 0x3fb8aa3b, v38
    v_mul_f32 v39, 0x3fb8aa3b, v39
    v_exp_f32 v36, v36
    v_exp_f32 v37, v37
    v_exp_f32 v38, v38
    v_exp_f32 v39, v39
    v_mul_f32 v19, v36, v44
    v_fma_f32 v19, v37, v45, v19
    v_fma_f32 v19, v38, v46, v19
    v_fma_f32 v19, v39, v47, v19
    v_perm_b32 v16, v16, v7, s56
    v_perm_b32 v17, v17, v7, s57
    v_perm_b32 v18, v18, v7, s58
    v_perm_b32 v19, v19, v7, s59
    s_mul_i32 s67, s28, 18432
    s_mul_i32 s64, s29, 1152
    s_add_u32 s67, s67, s64
    s_add_u32 s67, s67, 263168
    v_mov_b32 v6, s67
    s_lshl_b32 s64, s28, 8
    s_lshl_b32 s65, s29, 4
    s_add_u32 s64, s64, s65
    s_add_u32 s64, s64, 1835008
    v_mov_b32 v12, s64
    s_mov_b64 exec, 1
    global_store_dwordx4 v12, v[16:19], s[26:27]
    global_store_dwordx4 v6, v[16:19], s[26:27] sc1
    s_mov_b64 exec, -1
    v_mov_b32 v6, 0
    v_mov_b32 v12, 1
    ds_write_b32 v6, v12 offset:268
    s_branch L_roles
L_kmain:
    s_mov_b32 s56, 0x07060500
    s_mov_b32 s57, 0x07060501
    s_mov_b32 s58, 0x07060502
    s_mov_b32 s59, 0x07060503
    s_mov_b32 s62, 0x0c0c0400
    s_mov_b32 s63, 0x04000c0c
    s_waitcnt lgkmcnt(0)
    s_mul_i32 s31, s31, 0x19660d
    s_add_u32 s31, s31, 0x3c6ef35f
    v_mov_b32 v7, s31
    v_mov_b32 v6, 0
    s_mov_b32 s66, 0
L_qfloop:
    ds_read_b32 v12, v6 offset:256
    s_waitcnt lgkmcnt(0)
    v_cmp_ne_u32 vcc, 1, v12
    s_cbranch_vccz L_qfok
    s_add_u32 s66, s66, 1
    s_cmp_gt_u32 s66, 20000
    s_cbranch_scc1 L_qfok
    s_sleep 1
    s_branch L_qfloop
L_qfok:
    v_bfe_u32 v6, v1, 2, 1
    v_lshlrev_b32 v6, 8, v6
    v_lshlrev_b32 v12, 6, v3
    v_add_u32 v6, v6, v12
    v_and_b32 v12, 3, v1
    v_lshlrev_b32 v12, 4, v12
    v_add_u32 v6, v6, v12
    ds_read_b128 v[12:15], v6 offset:512
    s_waitcnt vmcnt(0) lgkmcnt(0)
    v_mfma_f32_16x16x32_bf16 v[96:99], v[12:15], v[32:35], 0
    v_mfma_f32_16x16x32_bf16 v[100:103], v[12:15], v[36:39], 0
    v_mfma_f32_16x16x32_bf16 v[104:107], v[12:15], v[40:43], 0
    v_mfma_f32_16x16x32_bf16 v[108:111], v[12:15], v[44:47], 0
    v_mfma_f32_16x16x32_bf16 v[112:115], v[12:15], v[48:51], 0
    v_mfma_f32_16x16x32_bf16 v[116:119], v[12:15], v[52:55], 0
    v_mfma_f32_16x16x32_bf16 v[24:27], v[12:15], v[56:59], 0
    v_mfma_f32_16x16x32_bf16 v[28:31], v[12:15], v[60:63], 0
    v_mfma_f32_16x16x32_bf16 v[32:35], v[12:15], v[64:67], 0
    v_mfma_f32_16x16x32_bf16 v[36:39], v[12:15], v[68:71], 0
    v_mfma_f32_16x16x32_bf16 v[40:43], v[12:15], v[72:75], 0
    v_mfma_f32_16x16x32_bf16 v[44:47], v[12:15], v[76:79], 0
    v_mfma_f32_16x16x32_bf16 v[48:51], v[12:15], v[80:83], 0
    v_mfma_f32_16x16x32_bf16 v[52:55], v[12:15], v[84:87], 0
    v_mfma_f32_16x16x32_bf16 v[56:59], v[12:15], v[88:91], 0
    v_mfma_f32_16x16x32_bf16 v[60:63], v[12:15], v[92:95], 0
    v_mov_b32_dpp v16, v96 quad_perm:[0,0,0,0] row_mask:0xf bank_mask:0xf
    v_mov_b32_dpp v17, v100 quad_perm:[0,0,0,0] row_mask:0xf bank_mask:0xf
    v_mov_b32_dpp v18, v104 quad_perm:[0,0,0,0] row_mask:0xf bank_mask:0xf
    v_mov_b32_dpp v19, v108 quad_perm:[0,0,0,0] row_mask:0xf bank_mask:0xf
    v_mov_b32_dpp v20, v112 quad_perm:[0,0,0,0] row_mask:0xf bank_mask:0xf
    v_mov_b32_dpp v21, v116 quad_perm:[0,0,0,0] row_mask:0xf bank_mask:0xf
    v_mov_b32_dpp v22, v24 quad_perm:[0,0,0,0] row_mask:0xf bank_mask:0xf
    v_mov_b32_dpp v23, v28 quad_perm:[0,0,0,0] row_mask:0xf bank_mask:0xf
    v_add_f32_dpp v16, v97, v16 quad_perm:[1,1,1,1] row_mask:0xf bank_mask:0xf
    v_add_f32_dpp v17, v101, v17 quad_perm:[1,1,1,1] row_mask:0xf bank_mask:0xf
    v_add_f32_dpp v18, v105, v18 quad_perm:[1,1,1,1] row_mask:0xf bank_mask:0xf
    v_add_f32_dpp v19, v109, v19 quad_perm:[1,1,1,1] row_mask:0xf bank_mask:0xf
    v_add_f32_dpp v20, v113, v20 quad_perm:[1,1,1,1] row_mask:0xf bank_mask:0xf
    v_add_f32_dpp v21, v117, v21 quad_perm:[1,1,1,1] row_mask:0xf bank_mask:0xf
    v_add_f32_dpp v22, v25, v22 quad_perm:[1,1,1,1] row_mask:0xf bank_mask:0xf
    v_add_f32_dpp v23, v29, v23 quad_perm:[1,1,1,1] row_mask:0xf bank_mask:0xf
    v_add_f32_dpp v16, v98, v16 quad_perm:[2,2,2,2] row_mask:0xf bank_mask:0xf
    v_add_f32_dpp v17, v102, v17 quad_perm:[2,2,2,2] row_mask:0xf bank_mask:0xf
    v_add_f32_dpp v18, v106, v18 quad_perm:[2,2,2,2] row_mask:0xf bank_mask:0xf
    v_add_f32_dpp v19, v110, v19 quad_perm:[2,2,2,2] row_mask:0xf bank_mask:0xf
    v_add_f32_dpp v20, v114, v20 quad_perm:[2,2,2,2] row_mask:0xf bank_mask:0xf
    v_add_f32_dpp v21, v118, v21 quad_perm:[2,2,2,2] row_mask:0xf bank_mask:0xf
    v_add_f32_dpp v22, v26, v22 quad_perm:[2,2,2,2] row_mask:0xf bank_mask:0xf
    v_add_f32_dpp v23, v30, v23 quad_perm:[2,2,2,2] row_mask:0xf bank_mask:0xf
    v_add_f32_dpp v16, v99, v16 quad_perm:[3,3,3,3] row_mask:0xf bank_mask:0xf
    v_add_f32_dpp v17, v103, v17 quad_perm:[3,3,3,3] row_mask:0xf bank_mask:0xf
    v_add_f32_dpp v18, v107, v18 quad_perm:[3,3,3,3] row_mask:0xf bank_mask:0xf
    v_add_f32_dpp v19, v111, v19 quad_perm:[3,3,3,3] row_mask:0xf bank_mask:0xf
    v_add_f32_dpp v20, v115, v20 quad_perm:[3,3,3,3] row_mask:0xf bank_mask:0xf
    v_add_f32_dpp v21, v119, v21 quad_perm:[3,3,3,3] row_mask:0xf bank_mask:0xf
    v_add_f32_dpp v22, v27, v22 quad_perm:[3,3,3,3] row_mask:0xf bank_mask:0xf
    v_add_f32_dpp v23, v31, v23 quad_perm:[3,3,3,3] row_mask:0xf bank_mask:0xf
    v_mov_b32_dpp v96, v32 quad_perm:[0,0,0,0] row_mask:0xf bank_mask:0xf
    v_mov_b32_dpp v97, v36 quad_perm:[0,0,0,0] row_mask:0xf bank_mask:0xf
    v_mov_b32_dpp v98, v40 quad_perm:[0,0,0,0] row_mask:0xf bank_mask:0xf
    v_mov_b32_dpp v99, v44 quad_perm:[0,0,0,0] row_mask:0xf bank_mask:0xf
    v_mov_b32_dpp v100, v48 quad_perm:[0,0,0,0] row_mask:0xf bank_mask:0xf
    v_mov_b32_dpp v101, v52 quad_perm:[0,0,0,0] row_mask:0xf bank_mask:0xf
    v_mov_b32_dpp v102, v56 quad_perm:[0,0,0,0] row_mask:0xf bank_mask:0xf
    v_mov_b32_dpp v103, v60 quad_perm:[0,0,0,0] row_mask:0xf bank_mask:0xf
    v_add_f32_dpp v96, v33, v96 quad_perm:[1,1,1,1] row_mask:0xf bank_mask:0xf
    v_add_f32_dpp v97, v37, v97 quad_perm:[1,1,1,1] row_mask:0xf bank_mask:0xf
    v_add_f32_dpp v98, v41, v98 quad_perm:[1,1,1,1] row_mask:0xf bank_mask:0xf
    v_add_f32_dpp v99, v45, v99 quad_perm:[1,1,1,1] row_mask:0xf bank_mask:0xf
    v_add_f32_dpp v100, v49, v100 quad_perm:[1,1,1,1] row_mask:0xf bank_mask:0xf
    v_add_f32_dpp v101, v53, v101 quad_perm:[1,1,1,1] row_mask:0xf bank_mask:0xf
    v_add_f32_dpp v102, v57, v102 quad_perm:[1,1,1,1] row_mask:0xf bank_mask:0xf
    v_add_f32_dpp v103, v61, v103 quad_perm:[1,1,1,1] row_mask:0xf bank_mask:0xf
    v_add_f32_dpp v96, v34, v96 quad_perm:[2,2,2,2] row_mask:0xf bank_mask:0xf
    v_add_f32_dpp v97, v38, v97 quad_perm:[2,2,2,2] row_mask:0xf bank_mask:0xf
    v_add_f32_dpp v98, v42, v98 quad_perm:[2,2,2,2] row_mask:0xf bank_mask:0xf
    v_add_f32_dpp v99, v46, v99 quad_perm:[2,2,2,2] row_mask:0xf bank_mask:0xf
    v_add_f32_dpp v100, v50, v100 quad_perm:[2,2,2,2] row_mask:0xf bank_mask:0xf
    v_add_f32_dpp v101, v54, v101 quad_perm:[2,2,2,2] row_mask:0xf bank_mask:0xf
    v_add_f32_dpp v102, v58, v102 quad_perm:[2,2,2,2] row_mask:0xf bank_mask:0xf
    v_add_f32_dpp v103, v62, v103 quad_perm:[2,2,2,2] row_mask:0xf bank_mask:0xf
    v_add_f32_dpp v96, v35, v96 quad_perm:[3,3,3,3] row_mask:0xf bank_mask:0xf
    v_add_f32_dpp v97, v39, v97 quad_perm:[3,3,3,3] row_mask:0xf bank_mask:0xf
    v_add_f32_dpp v98, v43, v98 quad_perm:[3,3,3,3] row_mask:0xf bank_mask:0xf
    v_add_f32_dpp v99, v47, v99 quad_perm:[3,3,3,3] row_mask:0xf bank_mask:0xf
    v_add_f32_dpp v100, v51, v100 quad_perm:[3,3,3,3] row_mask:0xf bank_mask:0xf
    v_add_f32_dpp v101, v55, v101 quad_perm:[3,3,3,3] row_mask:0xf bank_mask:0xf
    v_add_f32_dpp v102, v59, v102 quad_perm:[3,3,3,3] row_mask:0xf bank_mask:0xf
    v_add_f32_dpp v103, v63, v103 quad_perm:[3,3,3,3] row_mask:0xf bank_mask:0xf
    s_mov_b32 s64, 0x3db504f3
    v_cvt_pk_bf16_f32 v64, v16, v17
    v_cvt_pk_bf16_f32 v65, v18, v19
    v_cvt_pk_bf16_f32 v66, v20, v21
    v_cvt_pk_bf16_f32 v67, v22, v23
    v_cvt_pk_bf16_f32 v68, v96, v97
    v_cvt_pk_bf16_f32 v69, v98, v99
    v_cvt_pk_bf16_f32 v70, v100, v101
    v_cvt_pk_bf16_f32 v71, v102, v103
    v_lshlrev_b32 v16, 16, v64
    v_and_b32 v17, 0xffff0000, v64
    v_lshlrev_b32 v18, 16, v65
    v_and_b32 v19, 0xffff0000, v65
    v_lshlrev_b32 v20, 16, v66
    v_and_b32 v21, 0xffff0000, v66
    v_lshlrev_b32 v22, 16, v67
    v_and_b32 v23, 0xffff0000, v67
    v_lshlrev_b32 v96, 16, v68
    v_and_b32 v97, 0xffff0000, v68
    v_lshlrev_b32 v98, 16, v69
    v_and_b32 v99, 0xffff0000, v69
    v_lshlrev_b32 v100, 16, v70
    v_and_b32 v101, 0xffff0000, v70
    v_lshlrev_b32 v102, 16, v71
    v_and_b32 v103, 0xffff0000, v71
    v_mul_f32 v16, s64, v16
    v_mul_f32 v17, s64, v17
    v_mul_f32 v18, s64, v18
    v_mul_f32 v19, s64, v19
    v_mul_f32 v20, s64, v20
    v_mul_f32 v21, s64, v21
    v_mul_f32 v22, s64, v22
    v_mul_f32 v23, s64, v23
    v_mul_f32 v96, s64, v96
    v_mul_f32 v97, s64, v97
    v_mul_f32 v98, s64, v98
    v_mul_f32 v99, s64, v99
    v_mul_f32 v100, s64, v100
    v_mul_f32 v101, s64, v101
    v_mul_f32 v102, s64, v102
    v_mul_f32 v103, s64, v103
    v_cvt_pk_bf16_f32 v64, v16, v17
    v_cvt_pk_bf16_f32 v65, v18, v19
    v_cvt_pk_bf16_f32 v66, v20, v21
    v_cvt_pk_bf16_f32 v67, v22, v23
    v_cvt_pk_bf16_f32 v68, v96, v97
    v_cvt_pk_bf16_f32 v69, v98, v99
    v_cvt_pk_bf16_f32 v70, v100, v101
    v_cvt_pk_bf16_f32 v71, v102, v103
    v_lshlrev_b32 v16, 16, v64
    v_and_b32 v17, 0xffff0000, v64
    v_lshlrev_b32 v18, 16, v65
    v_and_b32 v19, 0xffff0000, v65
    v_lshlrev_b32 v20, 16, v66
    v_and_b32 v21, 0xffff0000, v66
    v_lshlrev_b32 v22, 16, v67
    v_and_b32 v23, 0xffff0000, v67
    v_lshlrev_b32 v96, 16, v68
    v_and_b32 v97, 0xffff0000, v68
    v_lshlrev_b32 v98, 16, v69
    v_and_b32 v99, 0xffff0000, v69
    v_lshlrev_b32 v100, 16, v70
    v_and_b32 v101, 0xffff0000, v70
    v_lshlrev_b32 v102, 16, v71
    v_and_b32 v103, 0xffff0000, v71
    v_max3_f32 v64, v16, v17, v18
    v_max3_f32 v65, v19, v20, v21
    v_max3_f32 v66, v22, v23, v96
    v_max3_f32 v67, v97, v98, v99
    v_max3_f32 v68, v100, v101, v102
    v_max3_f32 v64, v64, v65, v103
    v_max3_f32 v66, v66, v67, v68
    v_max_f32 v64, v64, v66
    s_nop 1
    v_max_f32_dpp v64, v64, v64 row_ror:8 row_mask:0xf bank_mask:0xf
    s_nop 1
    v_max_f32_dpp v64, v64, v64 row_ror:4 row_mask:0xf bank_mask:0xf
    s_mov_b32 s64, 0x3fb8aa3b
    v_sub_f32 v16, v16, v64
    v_sub_f32 v17, v17, v64
    v_sub_f32 v18, v18, v64
    v_sub_f32 v19, v19, v64
    v_sub_f32 v20, v20, v64
    v_sub_f32 v21, v21, v64
    v_sub_f32 v22, v22, v64
    v_sub_f32 v23, v23, v64
    v_sub_f32 v96, v96, v64
    v_sub_f32 v97, v97, v64
    v_sub_f32 v98, v98, v64
    v_sub_f32 v99, v99, v64
    v_sub_f32 v100, v100, v64
    v_sub_f32 v101, v101, v64
    v_sub_f32 v102, v102, v64
    v_sub_f32 v103, v103, v64
    v_mul_f32 v16, s64, v16
    v_mul_f32 v17, s64, v17
    v_mul_f32 v18, s64, v18
    v_mul_f32 v19, s64, v19
    v_mul_f32 v20, s64, v20
    v_mul_f32 v21, s64, v21
    v_mul_f32 v22, s64, v22
    v_mul_f32 v23, s64, v23
    v_mul_f32 v96, s64, v96
    v_mul_f32 v97, s64, v97
    v_mul_f32 v98, s64, v98
    v_mul_f32 v99, s64, v99
    v_mul_f32 v100, s64, v100
    v_mul_f32 v101, s64, v101
    v_mul_f32 v102, s64, v102
    v_mul_f32 v103, s64, v103
    v_exp_f32 v16, v16
    v_exp_f32 v17, v17
    v_exp_f32 v18, v18
    v_exp_f32 v19, v19
    v_exp_f32 v20, v20
    v_exp_f32 v21, v21
    v_exp_f32 v22, v22
    v_exp_f32 v23, v23
    v_exp_f32 v96, v96
    v_exp_f32 v97, v97
    v_exp_f32 v98, v98
    v_exp_f32 v99, v99
    v_exp_f32 v100, v100
    v_exp_f32 v101, v101
    v_exp_f32 v102, v102
    v_exp_f32 v103, v103
    v_cvt_pk_bf16_f32 v72, v16, v17
    v_cvt_pk_bf16_f32 v73, v18, v19
    v_cvt_pk_bf16_f32 v74, v20, v21
    v_cvt_pk_bf16_f32 v75, v22, v23
    v_cvt_pk_bf16_f32 v76, v96, v97
    v_cvt_pk_bf16_f32 v77, v98, v99
    v_cvt_pk_bf16_f32 v78, v100, v101
    v_cvt_pk_bf16_f32 v79, v102, v103
    v_add_f32 v16, v16, v17
    v_add_f32 v18, v18, v19
    v_add_f32 v20, v20, v21
    v_add_f32 v22, v22, v23
    v_add_f32 v96, v96, v97
    v_add_f32 v98, v98, v99
    v_add_f32 v100, v100, v101
    v_add_f32 v102, v102, v103
    v_add_f32 v16, v16, v18
    v_add_f32 v20, v20, v22
    v_add_f32 v96, v96, v98
    v_add_f32 v100, v100, v102
    v_add_f32 v16, v16, v20
    v_add_f32 v96, v96, v100
    v_add_f32 v65, v16, v96
    s_nop 1
    v_add_f32_dpp v65, v65, v65 row_ror:8 row_mask:0xf bank_mask:0xf
    s_nop 1
    v_add_f32_dpp v65, v65, v65 row_ror:4 row_mask:0xf bank_mask:0xf
    s_and_b32 s64, s30, 3
    v_lshlrev_b32 v6, 7, v3
    v_bfe_u32 v12, v1, 2, 2
    v_lshlrev_b32 v12, 5, v12
    v_add_u32 v6, v6, v12
    s_lshl_b32 s65, s64, 8
    v_add_u32 v6, s65, v6
    s_mov_b32 exec_lo, 0x11111111
    s_mov_b32 exec_hi, 0
    ds_write_b128 v6, v[72:75] offset:1280
    ds_write_b128 v6, v[76:79] offset:1296
    s_mov_b64 exec, -1
    s_lshl_b32 s65, s64, 2
    v_add_u32 v6, s65, v1
    s_mov_b64 exec, 0x10001
    ds_write_b32 v6, v64 offset:1024
    ds_write_b32 v6, v65 offset:1056
    s_mov_b64 exec, -1
    s_waitcnt lgkmcnt(0)
    s_barrier
    s_setprio 0
    v_mov_b32 v6, 0
    s_mov_b32 s66, 0
L_sfloop:
    ds_read_b32 v12, v6 offset:268
    s_waitcnt lgkmcnt(0)
    v_cmp_ne_u32 vcc, 1, v12
    s_cbranch_vccz L_sfok
    s_add_u32 s66, s66, 1
    s_cmp_gt_u32 s66, 20000
    s_cbranch_scc1 L_sfok
    s_sleep 2
    s_branch L_sfloop
L_sfok:
    s_cmp_lt_u32 s29, 9
    s_cbranch_scc1 L_kdA
    s_cmp_lt_u32 s29, 15
    s_cbranch_scc0 L_roles
    s_and_b32 s64, s30, 3
    s_lshl_b32 s64, s64, 1
    s_lshl_b32 s72, s28, 8
    s_lshl_b32 s65, s64, 5
    s_add_u32 s72, s72, s65
    s_mul_i32 s72, s72, 1152
    s_sub_u32 s65, s29, 9
    s_mul_i32 s65, s65, 192
    s_add_u32 s72, s72, s65
    s_mul_i32 s71, s64, 6144
    s_add_u32 s71, s71, 13312
    v_add_u32 v100, 0, v1
    v_mul_u32_u24 v101, 5462, v100
    v_lshrrev_b32 v101, 16, v101
    v_mul_u32_u24 v102, 12, v101
    v_sub_u32 v102, v100, v102
    v_bfe_u32 v103, v101, 3, 1
    v_lshlrev_b32 v103, 1, v103
    v_xor_b32 v102, v102, v103
    v_lshlrev_b32 v102, 4, v102
    v_mul_u32_u24 v101, 1152, v101
    v_add_u32 v104, v101, v102
    v_add_u32 v100, 64, v1
    v_mul_u32_u24 v101, 5462, v100
    v_lshrrev_b32 v101, 16, v101
    v_mul_u32_u24 v102, 12, v101
    v_sub_u32 v102, v100, v102
    v_bfe_u32 v103, v101, 3, 1
    v_lshlrev_b32 v103, 1, v103
    v_xor_b32 v102, v102, v103
    v_lshlrev_b32 v102, 4, v102
    v_mul_u32_u24 v101, 1152, v101
    v_add_u32 v105, v101, v102
    v_add_u32 v100, 128, v1
    v_mul_u32_u24 v101, 5462, v100
    v_lshrrev_b32 v101, 16, v101
    v_mul_u32_u24 v102, 12, v101
    v_sub_u32 v102, v100, v102
    v_bfe_u32 v103, v101, 3, 1
    v_lshlrev_b32 v103, 1, v103
    v_xor_b32 v102, v102, v103
    v_lshlrev_b32 v102, 4, v102
    v_mul_u32_u24 v101, 1152, v101
    v_add_u32 v106, v101, v102
    s_mov_b32 m0, s71
    s_add_u32 s71, s71, 1024
    buffer_load_dwordx4 v104, s[52:55], s72 offen nt lds
    s_mov_b32 m0, s71
    s_add_u32 s71, s71, 1024
    buffer_load_dwordx4 v105, s[52:55], s72 offen nt lds
    s_mov_b32 m0, s71
    s_add_u32 s71, s71, 1024
    buffer_load_dwordx4 v106, s[52:55], s72 offen nt lds
    s_add_u32 s72, s72, 18432
    s_mov_b32 m0, s71
    s_add_u32 s71, s71, 1024
    buffer_load_dwordx4 v104, s[52:55], s72 offen nt lds
    s_mov_b32 m0, s71
    s_add_u32 s71, s71, 1024
    buffer_load_dwordx4 v105, s[52:55], s72 offen nt lds
    s_mov_b32 m0, s71
    s_add_u32 s71, s71, 1024
    buffer_load_dwordx4 v106, s[52:55], s72 offen nt lds
    s_add_u32 s72, s72, 18432
    s_mov_b32 m0, s71
    s_add_u32 s71, s71, 1024
    buffer_load_dwordx4 v104, s[52:55], s72 offen nt lds
    s_mov_b32 m0, s71
    s_add_u32 s71, s71, 1024
    buffer_load_dwordx4 v105, s[52:55], s72 offen nt lds
    s_mov_b32 m0, s71
    s_add_u32 s71, s71, 1024
    buffer_load_dwordx4 v106, s[52:55], s72 offen nt lds
    s_add_u32 s72, s72, 18432
    s_mov_b32 m0, s71
    s_add_u32 s71, s71, 1024
    buffer_load_dwordx4 v104, s[52:55], s72 offen nt lds
    s_mov_b32 m0, s71
    s_add_u32 s71, s71, 1024
    buffer_load_dwordx4 v105, s[52:55], s72 offen nt lds
    s_mov_b32 m0, s71
    s_add_u32 s71, s71, 1024
    buffer_load_dwordx4 v106, s[52:55], s72 offen nt lds
    s_branch L_roles
L_kdA:
    s_mul_i32 s32, s28, 9
    s_add_u32 s32, s32, s29
    v_lshrrev_b32 v10, 2, v1
    v_mul_u32_u24 v10, 9216, v10
    v_and_b32 v12, 3, v1
    v_lshrrev_b32 v11, 5, v1
    v_lshlrev_b32 v11, 1, v11
    v_xor_b32 v12, v12, v11
    v_lshlrev_b32 v12, 4, v12
    v_add_u32 v10, v10, v12
    s_and_b32 s64, s30, 3
    s_mul_i32 s65, s64, 147456
    s_lshl_b32 s68, s32, 6
    s_add_u32 s68, s68, s65
    s_lshl_b32 s69, s64, 10
    s_add_u32 s69, s69, 13312
    v_lshrrev_b32 v14, 3, v1
    v_mul_u32_u24 v14, 1152, v14
    v_and_b32 v12, 7, v1
    v_bfe_u32 v11, v1, 4, 1
    v_lshlrev_b32 v11, 1, v11
    v_xor_b32 v12, v12, v11
    s_and_b32 s65, s64, 1
    s_lshl_b32 s65, s65, 2
    v_xor_b32 v12, s65, v12
    v_lshlrev_b32 v12, 4, v12
    v_add_u32 v14, v14, v12
    s_mul_i32 s75, s32, 36864
    s_mul_i32 s65, s64, 9216
    s_add_u32 s75, s75, s65
    s_and_b32 s64, s28, 1
    s_mul_i32 s64, s64, 9
    s_add_u32 s64, s64, s29
    s_lshl_b32 s64, s64, 5
    s_and_b32 s65, s30, 3
    s_lshl_b32 s65, s65, 3
    s_add_u32 s64, s64, s65
    s_mul_i32 s64, s64, 9216
    s_lshr_b32 s65, s28, 1
    s_mul_i32 s65, s65, 1152
    s_add_u32 s33, s64, s65
    v_lshrrev_b32 v100, 3, v1
    v_mul_u32_u24 v100, 9216, v100
    v_and_b32 v101, 7, v1
    v_lshlrev_b32 v101, 4, v101
    v_add_u32 v100, v100, v101
    v_add_u32 v100, 1024, v100
    s_mov_b32 s64, s33
    buffer_load_dwordx4 v[112:115], v8, s[80:83], s64 offen
    s_add_u32 s64, s64, 9216
    buffer_load_dwordx4 v[112:115], v8, s[80:83], s64 offen
    s_add_u32 s64, s64, 9216
    buffer_load_dwordx4 v[112:115], v8, s[80:83], s64 offen
    s_add_u32 s64, s64, 9216
    buffer_load_dwordx4 v[112:115], v8, s[80:83], s64 offen
    s_add_u32 s64, s64, 9216
    buffer_load_dwordx4 v[112:115], v8, s[80:83], s64 offen
    s_add_u32 s64, s64, 9216
    buffer_load_dwordx4 v[112:115], v8, s[80:83], s64 offen
    s_add_u32 s64, s64, 9216
    buffer_load_dwordx4 v[112:115], v8, s[80:83], s64 offen
    s_add_u32 s64, s64, 9216
    buffer_load_dwordx4 v[112:115], v8, s[80:83], s64 offen
    buffer_load_dwordx4 v[112:115], v100, s[80:83], s33 offen
    s_mov_b32 s64, s68
    s_add_u32 s65, s69, 0
    s_mov_b32 s73, s64
    s_mov_b32 s74, s65
    v_mov_b32 v6, 0
    s_mov_b32 s66, 0
L_wgloop:
    ds_read_b32 v12, v6 offset:264
    s_waitcnt lgkmcnt(0)
    v_cmp_ne_u32 vcc, 1, v12
    s_cbranch_vccz L_wgok
    s_add_u32 s66, s66, 1
    s_cmp_gt_u32 s66, 20000
    s_cbranch_scc1 L_wgok
    s_sleep 2
    s_branch L_wgloop
L_wgok:
    s_mov_b32 s64, s73
    s_mov_b32 s65, s74
    s_mov_b32 m0, s65
    s_add_u32 s65, s65, 4096
    buffer_load_dwordx4 v10, s[76:79], s64 offen nt lds
    s_add_u32 s64, s64, 589824
    s_mov_b32 m0, s65
    s_add_u32 s65, s65, 4096
    buffer_load_dwordx4 v10, s[76:79], s64 offen nt lds
    s_add_u32 s64, s64, 589824
    s_mov_b32 m0, s65
    s_add_u32 s65, s65, 4096
    buffer_load_dwordx4 v10, s[76:79], s64 offen nt lds
    s_add_u32 s64, s64, 589824
    s_mov_b32 m0, s65
    s_add_u32 s65, s65, 4096
    buffer_load_dwordx4 v10, s[76:79], s64 offen nt lds
    s_add_u32 s64, s64, 589824
    s_mov_b32 m0, s65
    s_add_u32 s65, s65, 4096
    buffer_load_dwordx4 v10, s[76:79], s64 offen nt lds
    s_add_u32 s64, s64, 589824
    s_mov_b32 m0, s65
    s_add_u32 s65, s65, 4096
    buffer_load_dwordx4 v10, s[76:79], s64 offen nt lds
    s_add_u32 s64, s64, 589824
    s_mov_b32 m0, s65
    s_add_u32 s65, s65, 4096
    buffer_load_dwordx4 v10, s[76:79], s64 offen nt lds
    s_add_u32 s64, s64, 589824
    s_mov_b32 m0, s65
    s_add_u32 s65, s65, 4096
    buffer_load_dwordx4 v10, s[76:79], s64 offen nt lds
    s_add_u32 s64, s64, 589824
    s_mov_b32 m0, s65
    s_add_u32 s65, s65, 4096
    buffer_load_dwordx4 v10, s[76:79], s64 offen nt lds
    s_waitcnt vmcnt(9)
    s_mov_b32 s64, s68
    s_add_u32 s65, s69, 36864
    s_mov_b32 m0, s65
    s_add_u32 s65, s65, 4096
    buffer_load_dwordx4 v10, s[80:83], s64 offen nt lds
    s_add_u32 s64, s64, 589824
    s_mov_b32 m0, s65
    s_add_u32 s65, s65, 4096
    buffer_load_dwordx4 v10, s[80:83], s64 offen nt lds
    s_add_u32 s64, s64, 589824
    s_mov_b32 m0, s65
    s_add_u32 s65, s65, 4096
    buffer_load_dwordx4 v10, s[80:83], s64 offen nt lds
    s_add_u32 s64, s64, 589824
    s_mov_b32 m0, s65
    s_add_u32 s65, s65, 4096
    buffer_load_dwordx4 v10, s[80:83], s64 offen nt lds
    s_add_u32 s64, s64, 589824
    s_mov_b32 m0, s65
    s_add_u32 s65, s65, 4096
    buffer_load_dwordx4 v10, s[80:83], s64 offen nt lds
    s_add_u32 s64, s64, 589824
    s_mov_b32 m0, s65
    s_add_u32 s65, s65, 4096
    buffer_load_dwordx4 v10, s[80:83], s64 offen nt lds
    s_add_u32 s64, s64, 589824
    s_mov_b32 m0, s65
    s_add_u32 s65, s65, 4096
    buffer_load_dwordx4 v10, s[80:83], s64 offen nt lds
    s_add_u32 s64, s64, 589824
    s_mov_b32 m0, s65
    s_add_u32 s65, s65, 4096
    buffer_load_dwordx4 v10, s[80:83], s64 offen nt lds
    s_add_u32 s64, s64, 589824
    s_mov_b32 m0, s65
    s_add_u32 s65, s65, 4096
    buffer_load_dwordx4 v10, s[80:83], s64 offen nt lds
    s_add_u32 s65, s69, 73728
    s_mov_b32 s64, s75
    s_mov_b32 m0, s65
    s_add_u32 s65, s65, 4096
    buffer_load_dwordx4 v14, s[84:87], s64 offen nt lds
    s_add_u32 s64, s64, 128
    s_mov_b32 m0, s65
    s_add_u32 s65, s65, 4096
    buffer_load_dwordx4 v14, s[84:87], s64 offen nt lds
    s_add_u32 s64, s64, 128
    s_mov_b32 m0, s65
    s_add_u32 s65, s65, 4096
    buffer_load_dwordx4 v14, s[84:87], s64 offen nt lds
    s_add_u32 s64, s64, 128
    s_mov_b32 m0, s65
    s_add_u32 s65, s65, 4096
    buffer_load_dwordx4 v14, s[84:87], s64 offen nt lds
    s_add_u32 s64, s64, 128
    s_mov_b32 m0, s65
    s_add_u32 s65, s65, 4096
    buffer_load_dwordx4 v14, s[84:87], s64 offen nt lds
    s_add_u32 s64, s64, 128
    s_mov_b32 m0, s65
    s_add_u32 s65, s65, 4096
    buffer_load_dwordx4 v14, s[84:87], s64 offen nt lds
    s_add_u32 s64, s64, 128
    s_mov_b32 m0, s65
    s_add_u32 s65, s65, 4096
    buffer_load_dwordx4 v14, s[84:87], s64 offen nt lds
    s_add_u32 s64, s64, 128
    s_mov_b32 m0, s65
    s_add_u32 s65, s65, 4096
    buffer_load_dwordx4 v14, s[84:87], s64 offen nt lds
    s_add_u32 s64, s64, 128
    s_mov_b32 m0, s65
    s_add_u32 s65, s65, 4096
    buffer_load_dwordx4 v14, s[84:87], s64 offen nt lds
    s_branch L_roles
L_vwave:
    s_cmp_eq_u32 s30, 1
    s_cbranch_scc0 L_nowarm
    s_lshl_b32 s64, s28, 13
    s_lshl_b32 s65, s29, 9
    s_add_u32 s64, s64, s65
    s_add_u32 s64, s64, 1114112
    s_lshl_b32 s65, s28, 14
    s_lshl_b32 s66, s29, 10
    s_add_u32 s65, s65, s66
    s_add_u32 s65, s65, 1572352
    s_lshl_b32 s66, s28, 8
    s_add_u32 s66, s66, 1833472
    v_lshlrev_b32 v12, 7, v1
    v_mov_b32 v6, s65
    v_mov_b32 v16, s64
    v_cmp_gt_u32 vcc, 4, v1
    s_nop 1
    v_cndmask_b32 v6, v6, v16, vcc
    v_mov_b32 v16, s66
    v_cmp_lt_u32 vcc, 11, v1
    s_nop 1
    v_cndmask_b32 v6, v6, v16, vcc
    v_add_u32 v6, v6, v12
    s_mov_b64 exec, 0x3fff
    global_load_dword v124, v6, s[26:27]
    s_mov_b64 exec, -1
L_nowarm:
    v_and_b32 v6, 1, v1
    v_lshlrev_b32 v6, 4, v6
    v_mov_b32 v12, 0xffff
    v_lshlrev_b32 v12, v6, v12
    v_bfe_u32 v6, v1, 1, 2
    v_cmp_eq_u32 vcc, 0, v6
    s_nop 1
    v_cndmask_b32 v120, 0, v12, vcc
    v_cmp_eq_u32 vcc, 1, v6
    s_nop 1
    v_cndmask_b32 v121, 0, v12, vcc
    v_cmp_eq_u32 vcc, 2, v6
    s_nop 1
    v_cndmask_b32 v122, 0, v12, vcc
    v_cmp_eq_u32 vcc, 3, v6
    s_nop 1
    v_cndmask_b32 v123, 0, v12, vcc
    s_mov_b32 s56, 0x07060500
    s_mov_b32 s57, 0x07060501
    s_mov_b32 s58, 0x07060502
    s_mov_b32 s59, 0x07060503
    s_mov_b32 s62, 0x0c0c0400
    s_mov_b32 s63, 0x04000c0c
    s_waitcnt lgkmcnt(0)
    s_mul_i32 s31, s31, 0x19660d
    s_add_u32 s31, s31, 0x3c6ef35f
    v_mov_b32 v7, s31
    s_barrier
    s_and_b32 s64, s2, 7
    s_mul_i32 s64, s64, 589824
    s_lshr_b32 s65, s2, 3
    s_mul_i32 s65, s65, 18432
    s_add_u32 s64, s64, s65
    s_and_b32 s65, s30, 3
    s_mul_i32 s65, s65, 4608
    s_add_u32 s64, s64, s65
    buffer_load_dwordx4 v[112:115], v8, s[52:55], s64 offen offset:0
    buffer_load_dwordx4 v[112:115], v8, s[52:55], s64 offen offset:1024
    buffer_load_dwordx4 v[112:115], v8, s[52:55], s64 offen offset:2048
    buffer_load_dwordx4 v[112:115], v8, s[52:55], s64 offen offset:3072
    s_add_u32 s64, s64, 4096
    s_mov_b32 exec_lo, -1
    s_mov_b32 exec_hi, 0x0
    buffer_load_dwordx4 v[112:115], v8, s[52:55], s64 offen offset:0
    s_mov_b64 exec, -1
    s_lshr_b32 s64, s2, 3
    s_mul_i32 s64, s64, 18
    s_and_b32 s65, s30, 3
    s_add_u32 s73, s64, s65
    s_add_u32 s74, s64, 17
    s_and_b32 s65, s2, 7
    s_mul_i32 s75, s65, 1152
    v_lshrrev_b32 v100, 3, v1
    v_lshlrev_b32 v100, 2, v100
    v_add_u32 v100, s73, v100
    v_min_u32 v100, s74, v100
    v_mul_u32_u24 v100, 9216, v100
    v_and_b32 v101, 7, v1
    v_lshlrev_b32 v101, 4, v101
    v_add_u32 v100, v100, v101
    v_add_u32 v100, 1024, v100
    s_add_u32 s64, s73, 0
    s_mul_i32 s64, s64, 9216
    s_add_u32 s64, s64, s75
    buffer_load_dwordx4 v[112:115], v8, s[76:79], s64 offen
    s_add_u32 s64, s73, 4
    s_mul_i32 s64, s64, 9216
    s_add_u32 s64, s64, s75
    buffer_load_dwordx4 v[112:115], v8, s[76:79], s64 offen
    s_add_u32 s64, s73, 8
    s_mul_i32 s64, s64, 9216
    s_add_u32 s64, s64, s75
    buffer_load_dwordx4 v[112:115], v8, s[76:79], s64 offen
    s_add_u32 s64, s73, 12
    s_mul_i32 s64, s64, 9216
    s_add_u32 s64, s64, s75
    buffer_load_dwordx4 v[112:115], v8, s[76:79], s64 offen
    s_and_b32 s65, s30, 3
    s_cmp_lt_u32 s65, 2
    s_cbranch_scc0 L_pfkg
    s_add_u32 s64, s73, 16
    s_mul_i32 s64, s64, 9216
    s_add_u32 s64, s64, s75
    buffer_load_dwordx4 v[112:115], v8, s[76:79], s64 offen
L_pfkg:
    s_mov_b32 exec_lo, -1
    s_mov_b32 exec_hi, 0xff
    buffer_load_dwordx4 v[112:115], v100, s[76:79], s75 offen
    s_mov_b64 exec, -1
    buffer_load_dwordx4 v[32:35], v8, s[44:47], 0 offen offset:0 nt
    buffer_load_dwordx4 v[36:39], v8, s[44:47], 0 offen offset:1024 nt
    buffer_load_dwordx4 v[40:43], v8, s[44:47], 0 offen offset:2048 nt
    buffer_load_dwordx4 v[44:47], v8, s[44:47], 0 offen offset:3072 nt
    buffer_load_dwordx4 v[48:51], v8, s[44:47], s70 offen offset:0 nt
    buffer_load_dwordx4 v[52:55], v8, s[44:47], s70 offen offset:1024 nt
    buffer_load_dwordx4 v[56:59], v8, s[44:47], s70 offen offset:2048 nt
    buffer_load_dwordx4 v[60:63], v8, s[44:47], s70 offen offset:3072 nt
    buffer_load_dwordx4 v[64:67], v8, s[44:47], s71 offen offset:0 nt
    buffer_load_dwordx4 v[68:71], v8, s[44:47], s71 offen offset:1024 nt
    buffer_load_dwordx4 v[72:75], v8, s[44:47], s71 offen offset:2048 nt
    buffer_load_dwordx4 v[76:79], v8, s[44:47], s71 offen offset:3072 nt
    buffer_load_dwordx4 v[80:83], v8, s[44:47], s72 offen offset:0 nt
    buffer_load_dwordx4 v[84:87], v8, s[44:47], s72 offen offset:1024 nt
    buffer_load_dwordx4 v[88:91], v8, s[44:47], s72 offen offset:2048 nt
    buffer_load_dwordx4 v[92:95], v8, s[44:47], s72 offen offset:3072 nt
    s_barrier
    v_bfe_u32 v6, v1, 3, 1
    v_lshlrev_b32 v6, 7, v6
    v_lshlrev_b32 v12, 5, v3
    v_add_u32 v6, v6, v12
    s_lshl_b32 s64, s30, 8
    v_add_u32 v6, s64, v6
    ds_read_b128 v[16:19], v6 offset:1280
    ds_read_b128 v[20:23], v6 offset:1296
    v_lshrrev_b32 v6, 1, v3
    v_lshlrev_b32 v6, 4, v6
    ds_read_b128 v[24:27], v6 offset:1024
    s_lshl_b32 s64, s30, 2
    v_add_u32 v6, s64, v6
    ds_read_b32 v28, v6 offset:1024
    s_waitcnt lgkmcnt(0)
    v_max3_f32 v24, v24, v25, v26
    v_max_f32 v24, v24, v27
    v_sub_f32 v28, v28, v24
    v_mul_f32 v28, 0x3fb8aa3b, v28
    v_exp_f32 v28, v28
    s_mov_b32 s64, 0x01000100
    s_mov_b32 s65, 0x03020302
    v_perm_b32 v29, v16, v16, s64
    v_and_b32 v96, v29, v120
    v_and_b32 v97, v29, v121
    v_and_b32 v98, v29, v122
    v_and_b32 v99, v29, v123
    s_waitcnt vmcnt(15)
    s_nop 0
    v_mfma_f32_16x16x32_bf16 v[12:15], v[96:99], v[32:35], 0
    v_perm_b32 v29, v16, v16, s65
    v_and_b32 v100, v29, v120
    v_and_b32 v101, v29, v121
    v_and_b32 v102, v29, v122
    v_and_b32 v103, v29, v123
    s_waitcnt vmcnt(14)
    s_nop 0
    v_mfma_f32_16x16x32_bf16 v[12:15], v[100:103], v[36:39], v[12:15]
    v_perm_b32 v29, v17, v17, s64
    v_and_b32 v104, v29, v120
    v_and_b32 v105, v29, v121
    v_and_b32 v106, v29, v122
    v_and_b32 v107, v29, v123
    s_waitcnt vmcnt(13)
    s_nop 0
    v_mfma_f32_16x16x32_bf16 v[12:15], v[104:107], v[40:43], v[12:15]
    v_perm_b32 v29, v17, v17, s65
    v_and_b32 v108, v29, v120
    v_and_b32 v109, v29, v121
    v_and_b32 v110, v29, v122
    v_and_b32 v111, v29, v123
    s_waitcnt vmcnt(12)
    s_nop 0
    v_mfma_f32_16x16x32_bf16 v[12:15], v[108:111], v[44:47], v[12:15]
    v_perm_b32 v29, v18, v18, s64
    v_and_b32 v96, v29, v120
    v_and_b32 v97, v29, v121
    v_and_b32 v98, v29, v122
    v_and_b32 v99, v29, v123
    s_waitcnt vmcnt(11)
    s_nop 0
    v_mfma_f32_16x16x32_bf16 v[12:15], v[96:99], v[48:51], v[12:15]
    v_perm_b32 v29, v18, v18, s65
    v_and_b32 v100, v29, v120
    v_and_b32 v101, v29, v121
    v_and_b32 v102, v29, v122
    v_and_b32 v103, v29, v123
    s_waitcnt vmcnt(10)
    s_nop 0
    v_mfma_f32_16x16x32_bf16 v[12:15], v[100:103], v[52:55], v[12:15]
    v_perm_b32 v29, v19, v19, s64
    v_and_b32 v104, v29, v120
    v_and_b32 v105, v29, v121
    v_and_b32 v106, v29, v122
    v_and_b32 v107, v29, v123
    s_waitcnt vmcnt(9)
    s_nop 0
    v_mfma_f32_16x16x32_bf16 v[12:15], v[104:107], v[56:59], v[12:15]
    v_perm_b32 v29, v19, v19, s65
    v_and_b32 v108, v29, v120
    v_and_b32 v109, v29, v121
    v_and_b32 v110, v29, v122
    v_and_b32 v111, v29, v123
    s_waitcnt vmcnt(8)
    s_nop 0
    v_mfma_f32_16x16x32_bf16 v[12:15], v[108:111], v[60:63], v[12:15]
    v_perm_b32 v29, v20, v20, s64
    v_and_b32 v96, v29, v120
    v_and_b32 v97, v29, v121
    v_and_b32 v98, v29, v122
    v_and_b32 v99, v29, v123
    s_waitcnt vmcnt(7)
    s_nop 0
    v_mfma_f32_16x16x32_bf16 v[12:15], v[96:99], v[64:67], v[12:15]
    v_perm_b32 v29, v20, v20, s65
    v_and_b32 v100, v29, v120
    v_and_b32 v101, v29, v121
    v_and_b32 v102, v29, v122
    v_and_b32 v103, v29, v123
    s_waitcnt vmcnt(6)
    s_nop 0
    v_mfma_f32_16x16x32_bf16 v[12:15], v[100:103], v[68:71], v[12:15]
    v_perm_b32 v29, v21, v21, s64
    v_and_b32 v104, v29, v120
    v_and_b32 v105, v29, v121
    v_and_b32 v106, v29, v122
    v_and_b32 v107, v29, v123
    s_waitcnt vmcnt(5)
    s_nop 0
    v_mfma_f32_16x16x32_bf16 v[12:15], v[104:107], v[72:75], v[12:15]
    v_perm_b32 v29, v21, v21, s65
    v_and_b32 v108, v29, v120
    v_and_b32 v109, v29, v121
    v_and_b32 v110, v29, v122
    v_and_b32 v111, v29, v123
    s_waitcnt vmcnt(4)
    s_nop 0
    v_mfma_f32_16x16x32_bf16 v[12:15], v[108:111], v[76:79], v[12:15]
    v_perm_b32 v29, v22, v22, s64
    v_and_b32 v96, v29, v120
    v_and_b32 v97, v29, v121
    v_and_b32 v98, v29, v122
    v_and_b32 v99, v29, v123
    s_waitcnt vmcnt(3)
    s_nop 0
    v_mfma_f32_16x16x32_bf16 v[12:15], v[96:99], v[80:83], v[12:15]
    v_perm_b32 v29, v22, v22, s65
    v_and_b32 v100, v29, v120
    v_and_b32 v101, v29, v121
    v_and_b32 v102, v29, v122
    v_and_b32 v103, v29, v123
    s_waitcnt vmcnt(2)
    s_nop 0
    v_mfma_f32_16x16x32_bf16 v[12:15], v[100:103], v[84:87], v[12:15]
    v_perm_b32 v29, v23, v23, s64
    v_and_b32 v104, v29, v120
    v_and_b32 v105, v29, v121
    v_and_b32 v106, v29, v122
    v_and_b32 v107, v29, v123
    s_waitcnt vmcnt(1)
    s_nop 0
    v_mfma_f32_16x16x32_bf16 v[12:15], v[104:107], v[88:91], v[12:15]
    v_perm_b32 v29, v23, v23, s65
    v_and_b32 v108, v29, v120
    v_and_b32 v109, v29, v121
    v_and_b32 v110, v29, v122
    v_and_b32 v111, v29, v123
    s_waitcnt vmcnt(0)
    s_nop 0
    v_mfma_f32_16x16x32_bf16 v[12:15], v[108:111], v[92:95], v[12:15]
    s_setprio 3
    v_lshrrev_b32 v6, 1, v3
    v_lshlrev_b32 v6, 9, v6
    v_lshlrev_b32 v30, 5, v2
    v_add_u32 v6, v6, v30
    v_and_b32 v30, 1, v3
    v_lshlrev_b32 v30, 4, v30
    v_add_u32 v6, v6, v30
    s_lshl_b32 s64, s30, 10
    v_add_u32 v6, s64, v6
    v_mul_f32 v12, v28, v12
    v_mul_f32 v13, v28, v13
    v_mul_f32 v14, v28, v14
    v_mul_f32 v15, v28, v15
    ds_write_b128 v6, v[12:15] offset:2560
    v_mov_b32 v6, 0
    v_mov_b32 v30, 1
    s_mov_b64 exec, 1
    ds_add_rtn_u32 v31, v6, v30 offset:260
    s_mov_b64 exec, -1
    s_waitcnt lgkmcnt(0)
    v_readfirstlane_b32 s64, v31
    s_cmp_eq_u32 s64, 3
    s_cbranch_scc0 L_vdone
    ds_read_b128 v[16:19], v8 offset:2560
    ds_read_b128 v[20:23], v8 offset:3584
    ds_read_b128 v[24:27], v8 offset:4608
    ds_read_b128 v[28:31], v8 offset:5632
    s_mul_i32 s67, s28, 18432
    s_mul_i32 s64, s29, 1152
    s_add_u32 s67, s67, s64
    s_add_u32 s67, s67, 262144
    v_add_u32 v6, s67, v8
    s_lshl_b32 s64, s28, 14
    s_lshl_b32 s65, s29, 4
    s_add_u32 s64, s64, s65
    s_add_u32 s64, s64, 1572864
    v_lshrrev_b32 v12, 3, v1
    v_lshlrev_b32 v12, 11, v12
    v_and_b32 v13, 1, v1
    v_lshlrev_b32 v13, 10, v13
    v_add_u32 v12, v12, v13
    v_bfe_u32 v13, v1, 1, 2
    v_lshlrev_b32 v13, 8, v13
    v_add_u32 v12, v12, v13
    v_add_u32 v12, s64, v12
    s_waitcnt lgkmcnt(0)
    v_add_f32 v16, v16, v20
    v_add_f32 v24, v24, v28
    v_add_f32 v17, v17, v21
    v_add_f32 v25, v25, v29
    v_add_f32 v18, v18, v22
    v_add_f32 v26, v26, v30
    v_add_f32 v19, v19, v23
    v_add_f32 v27, v27, v31
    v_add_f32 v16, v16, v24
    v_add_f32 v17, v17, v25
    v_add_f32 v18, v18, v26
    v_add_f32 v19, v19, v27
    v_perm_b32 v16, v16, v7, s56
    v_perm_b32 v17, v17, v7, s57
    v_perm_b32 v18, v18, v7, s58
    v_perm_b32 v19, v19, v7, s59
    global_store_dwordx4 v12, v[16:19], s[26:27]
    global_store_dwordx4 v6, v[16:19], s[26:27] sc1
    v_mov_b32 v6, 0
    v_mov_b32 v30, 1
    ds_write_b32 v6, v30 offset:264
L_vdone:
    s_setprio 0
    s_branch L_roles
L_roles:
    s_cmp_lt_u32 s29, 9
    s_cbranch_scc1 L_roleA
    s_cmp_lt_u32 s29, 15
    s_cbranch_scc0 L_fin
    s_mul_i32 s64, s28, 18432
    s_add_u32 s64, s64, 262144
    s_cmp_eq_u32 s30, 8
    s_cbranch_scc0 L_b1w
    v_mul_u32_u24 v9, 1152, v2
    v_add_u32 v9, s64, v9
    v_add_u32 v9, 1024, v9
    s_lshl_b32 s65, s28, 8
    s_add_u32 s65, s65, 1835008
    v_lshlrev_b32 v6, 4, v2
    v_add_u32 v6, s65, v6
    s_sleep 2
    s_mov_b32 s66, 0
L_stloop:
    global_load_dwordx4 v[72:75], v6, s[26:27] sc1
    s_waitcnt vmcnt(0)
    v_perm_b32 v100, v73, v72, s62
    v_perm_b32 v101, v75, v74, s63
    v_or_b32 v100, v100, v101
    v_cmp_ne_u32 vcc, v100, v7
    s_cbranch_vccz L_stok
    s_add_u32 s66, s66, 1
    s_cmp_gt_u32 s66, 20000
    s_cbranch_scc1 L_stok
    s_cmp_eq_u32 s66, 6
    s_cbranch_scc0 L_stkeep
    v_mov_b32 v6, v9
L_stkeep:
    s_sleep 2
    s_branch L_stloop
L_stok:
    v_and_b32 v12, 1, v3
    v_cmp_eq_u32 vcc, 1, v12
    s_nop 1
    v_cndmask_b32 v72, v72, v74, vcc
    v_cndmask_b32 v73, v73, v75, vcc
    v_and_b32 v72, 0xffffff00, v72
    v_and_b32 v73, 0xffffff00, v73
    v_mov_b32 v76, v72
    s_nop 1
    v_max_f32_dpp v76, v76, v76 row_ror:8 row_mask:0xf bank_mask:0xf
    s_nop 1
    v_max_f32_dpp v76, v76, v76 row_ror:4 row_mask:0xf bank_mask:0xf
    s_nop 1
    v_max_f32_dpp v76, v76, v76 row_ror:2 row_mask:0xf bank_mask:0xf
    s_nop 1
    v_max_f32_dpp v76, v76, v76 row_ror:1 row_mask:0xf bank_mask:0xf
    v_sub_f32 v72, v72, v76
    v_mul_f32 v72, 0x3fb8aa3b, v72
    v_exp_f32 v72, v72
    s_nop 0
    v_mul_f32 v73, v72, v73
    s_nop 1
    v_add_f32_dpp v73, v73, v73 row_ror:8 row_mask:0xf bank_mask:0xf
    s_nop 1
    v_add_f32_dpp v73, v73, v73 row_ror:4 row_mask:0xf bank_mask:0xf
    s_nop 1
    v_add_f32_dpp v73, v73, v73 row_ror:2 row_mask:0xf bank_mask:0xf
    s_nop 1
    v_add_f32_dpp v73, v73, v73 row_ror:1 row_mask:0xf bank_mask:0xf
    v_rcp_f32 v73, v73
    s_nop 0
    v_mul_f32 v72, v72, v73
    v_lshlrev_b32 v6, 2, v1
    s_mov_b32 exec_lo, -1
    s_mov_b32 exec_hi, 0
    ds_write_b32 v6, v72 offset:10816
    s_mov_b64 exec, -1
    s_setprio 0
    s_waitcnt lgkmcnt(0)
    s_barrier
    s_branch L_b1w8
L_b1w:
    v_mul_u32_u24 v15, 1152, v2
    v_add_u32 v15, s64, v15
    v_lshlrev_b32 v12, 5, v3
    s_lshl_b32 s65, s30, 7
    v_add_u32 v12, s65, v12
    v_add_u32 v15, v15, v12
    s_lshl_b32 s64, s28, 14
    s_lshl_b32 s65, s30, 11
    s_add_u32 s64, s64, s65
    s_add_u32 s64, s64, 1572864
    v_add_u32 v6, s64, v8
    v_add_u32 v14, 1024, v6
    v_lshlrev_b32 v10, 3, v3
    v_bfe_u32 v12, v1, 2, 2
    v_add_u32 v10, v10, v12
    v_mul_u32_u24 v10, 192, v10
    v_and_b32 v12, 3, v1
    v_lshlrev_b32 v12, 3, v12
    v_add_u32 v10, v10, v12
    s_mul_i32 s65, s30, 6144
    s_add_u32 s65, s65, 13312
    v_add_u32 v10, s65, v10
    v_and_b32 v12, 1, v3
    v_lshlrev_b32 v12, 5, v12
    v_add_u32 v11, v10, v12
    v_sub_u32 v10, v10, v12
    s_lshr_b32 s65, s30, 2
    s_lshl_b32 s65, s65, 6
    v_lshlrev_b32 v9, 2, v2
    v_add_u32 v9, s65, v9
    v_lshlrev_b32 v13, 4, v3
    s_mul_i32 s65, s30, 384
    v_add_u32 v13, s65, v13
    s_waitcnt vmcnt(0)
    s_barrier
    ds_read_b32 v72, v9 offset:10816
    ds_read_b64_tr_b16 v[32:33], v11 offset:0
    ds_read_b64_tr_b16 v[34:35], v11 offset:768
    ds_read_b64_tr_b16 v[36:37], v10 offset:32
    ds_read_b64_tr_b16 v[38:39], v10 offset:800
    ds_read_b64_tr_b16 v[40:41], v11 offset:64
    ds_read_b64_tr_b16 v[42:43], v11 offset:832
    ds_read_b64_tr_b16 v[44:45], v10 offset:96
    ds_read_b64_tr_b16 v[46:47], v10 offset:864
    ds_read_b64_tr_b16 v[48:49], v11 offset:128
    ds_read_b64_tr_b16 v[50:51], v11 offset:896
    ds_read_b64_tr_b16 v[52:53], v10 offset:160
    ds_read_b64_tr_b16 v[54:55], v10 offset:928
    s_mov_b32 s66, 0
    global_load_dwordx4 v[64:67], v6, s[26:27] sc1
    global_load_dwordx4 v[68:71], v14, s[26:27] sc1
L_h2loop:
    s_waitcnt vmcnt(0)
    v_perm_b32 v100, v65, v64, s62
    v_perm_b32 v101, v67, v66, s63
    v_or_b32 v100, v100, v101
    v_cmp_ne_u32 vcc, v100, v7
    s_mov_b64 s[60:61], vcc
    v_perm_b32 v100, v69, v68, s62
    v_perm_b32 v101, v71, v70, s63
    v_or_b32 v100, v100, v101
    v_cmp_ne_u32 vcc, v100, v7
    s_or_b64 s[60:61], s[60:61], vcc
    s_mov_b64 vcc, s[60:61]
    s_cbranch_vccz L_h2ok
    s_add_u32 s66, s66, 1
    s_cmp_gt_u32 s66, 20000
    s_cbranch_scc1 L_h2ok
    s_cmp_eq_u32 s66, 6
    s_cbranch_scc0 L_h2keep
    v_mov_b32 v6, v15
    v_add_u32 v14, 16, v15
L_h2keep:
    global_load_dwordx4 v[64:67], v6, s[26:27] sc1
    global_load_dwordx4 v[68:71], v14, s[26:27] sc1
    s_branch L_h2loop
L_h2ok:
    s_waitcnt lgkmcnt(0)
    v_mul_f32 v64, v72, v64
    v_mul_f32 v65, v72, v65
    v_mul_f32 v66, v72, v66
    v_mul_f32 v67, v72, v67
    v_mul_f32 v68, v72, v68
    v_mul_f32 v69, v72, v69
    v_mul_f32 v70, v72, v70
    v_mul_f32 v71, v72, v71
    v_add_f32_dpp v64, v64, v64 row_ror:8 row_mask:0xf bank_mask:0xf
    v_add_f32_dpp v65, v65, v65 row_ror:8 row_mask:0xf bank_mask:0xf
    v_add_f32_dpp v66, v66, v66 row_ror:8 row_mask:0xf bank_mask:0xf
    v_add_f32_dpp v67, v67, v67 row_ror:8 row_mask:0xf bank_mask:0xf
    v_add_f32_dpp v68, v68, v68 row_ror:8 row_mask:0xf bank_mask:0xf
    v_add_f32_dpp v69, v69, v69 row_ror:8 row_mask:0xf bank_mask:0xf
    v_add_f32_dpp v70, v70, v70 row_ror:8 row_mask:0xf bank_mask:0xf
    v_add_f32_dpp v71, v71, v71 row_ror:8 row_mask:0xf bank_mask:0xf
    v_add_f32_dpp v64, v64, v64 row_ror:4 row_mask:0xf bank_mask:0xf
    v_add_f32_dpp v65, v65, v65 row_ror:4 row_mask:0xf bank_mask:0xf
    v_add_f32_dpp v66, v66, v66 row_ror:4 row_mask:0xf bank_mask:0xf
    v_add_f32_dpp v67, v67, v67 row_ror:4 row_mask:0xf bank_mask:0xf
    v_add_f32_dpp v68, v68, v68 row_ror:4 row_mask:0xf bank_mask:0xf
    v_add_f32_dpp v69, v69, v69 row_ror:4 row_mask:0xf bank_mask:0xf
    v_add_f32_dpp v70, v70, v70 row_ror:4 row_mask:0xf bank_mask:0xf
    v_add_f32_dpp v71, v71, v71 row_ror:4 row_mask:0xf bank_mask:0xf
    v_add_f32_dpp v64, v64, v64 row_ror:2 row_mask:0xf bank_mask:0xf
    v_add_f32_dpp v65, v65, v65 row_ror:2 row_mask:0xf bank_mask:0xf
    v_add_f32_dpp v66, v66, v66 row_ror:2 row_mask:0xf bank_mask:0xf
    v_add_f32_dpp v67, v67, v67 row_ror:2 row_mask:0xf bank_mask:0xf
    v_add_f32_dpp v68, v68, v68 row_ror:2 row_mask:0xf bank_mask:0xf
    v_add_f32_dpp v69, v69, v69 row_ror:2 row_mask:0xf bank_mask:0xf
    v_add_f32_dpp v70, v70, v70 row_ror:2 row_mask:0xf bank_mask:0xf
    v_add_f32_dpp v71, v71, v71 row_ror:2 row_mask:0xf bank_mask:0xf
    v_add_f32_dpp v64, v64, v64 row_ror:1 row_mask:0xf bank_mask:0xf
    v_add_f32_dpp v65, v65, v65 row_ror:1 row_mask:0xf bank_mask:0xf
    v_add_f32_dpp v66, v66, v66 row_ror:1 row_mask:0xf bank_mask:0xf
    v_add_f32_dpp v67, v67, v67 row_ror:1 row_mask:0xf bank_mask:0xf
    v_add_f32_dpp v68, v68, v68 row_ror:1 row_mask:0xf bank_mask:0xf
    v_add_f32_dpp v69, v69, v69 row_ror:1 row_mask:0xf bank_mask:0xf
    v_add_f32_dpp v70, v70, v70 row_ror:1 row_mask:0xf bank_mask:0xf
    v_add_f32_dpp v71, v71, v71 row_ror:1 row_mask:0xf bank_mask:0xf
    v_cvt_pk_bf16_f32 v76, v64, v65
    v_cvt_pk_bf16_f32 v77, v66, v67
    v_cvt_pk_bf16_f32 v78, v68, v69
    v_cvt_pk_bf16_f32 v79, v70, v71
    s_waitcnt lgkmcnt(0)
    s_nop 0
    v_mfma_f32_16x16x32_bf16 v[80:83], v[32:35], v[76:79], 0
    v_mfma_f32_16x16x32_bf16 v[84:87], v[36:39], v[76:79], 0
    v_mfma_f32_16x16x32_bf16 v[88:91], v[40:43], v[76:79], 0
    v_mfma_f32_16x16x32_bf16 v[92:95], v[44:47], v[76:79], 0
    v_mfma_f32_16x16x32_bf16 v[96:99], v[48:51], v[76:79], 0
    v_mfma_f32_16x16x32_bf16 v[100:103], v[52:55], v[76:79], 0
    s_mov_b32 s64, 0x00010001
    s_mov_b32 s65, 0x00010001
    s_mov_b64 exec, s[64:65]
    ds_write_b128 v13, v[80:83] offset:6656
    ds_write_b128 v13, v[84:87] offset:6720
    ds_write_b128 v13, v[88:91] offset:6784
    ds_write_b128 v13, v[92:95] offset:6848
    ds_write_b128 v13, v[96:99] offset:6912
    ds_write_b128 v13, v[100:103] offset:6976
    s_mov_b64 exec, -1
L_b1w8:
    s_waitcnt lgkmcnt(0)
    s_barrier
    s_cmp_lt_u32 s30, 3
    s_cbranch_scc0 L_b1pubdone
    v_and_b32 v6, 7, v1
    v_lshlrev_b32 v6, 4, v6
    v_lshrrev_b32 v12, 3, v1
    v_mul_u32_u24 v12, 384, v12
    v_add_u32 v6, v6, v12
    s_lshl_b32 s64, s30, 7
    v_add_u32 v6, s64, v6
    ds_read_b128 v[16:19], v6 offset:6656
    s_mul_i32 s64, s28, 2304
    s_sub_u32 s65, s29, 9
    s_mul_i32 s65, s65, 384
    s_add_u32 s64, s64, s65
    s_lshl_b32 s65, s30, 7
    s_add_u32 s64, s64, s65
    s_add_u32 s64, s64, 2097152
    v_and_b32 v6, 7, v1
    v_lshlrev_b32 v6, 4, v6
    v_add_u32 v6, s64, v6
    v_lshrrev_b32 v12, 3, v1
    v_mul_u32_u24 v12, 36864, v12
    v_add_u32 v6, v6, v12
    s_waitcnt lgkmcnt(0)
    v_add_f32_dpp v16, v16, v16 row_ror:8 row_mask:0xf bank_mask:0xf
    v_add_f32_dpp v17, v17, v17 row_ror:8 row_mask:0xf bank_mask:0xf
    v_add_f32_dpp v18, v18, v18 row_ror:8 row_mask:0xf bank_mask:0xf
    v_add_f32_dpp v19, v19, v19 row_ror:8 row_mask:0xf bank_mask:0xf
    v_mov_b32 v20, v16
    v_mov_b32 v21, v17
    v_mov_b32 v22, v18
    v_mov_b32 v23, v19
    v_permlane16_swap_b32 v16, v20
    v_permlane16_swap_b32 v17, v21
    v_permlane16_swap_b32 v18, v22
    v_permlane16_swap_b32 v19, v23
    v_add_f32 v16, v16, v20
    v_add_f32 v17, v17, v21
    v_add_f32 v18, v18, v22
    v_add_f32 v19, v19, v23
    v_mov_b32 v20, v16
    v_mov_b32 v21, v17
    v_mov_b32 v22, v18
    v_mov_b32 v23, v19
    v_permlane32_swap_b32 v16, v20
    v_permlane32_swap_b32 v17, v21
    v_permlane32_swap_b32 v18, v22
    v_permlane32_swap_b32 v19, v23
    v_add_f32 v16, v16, v20
    v_add_f32 v17, v17, v21
    v_add_f32 v18, v18, v22
    v_add_f32 v19, v19, v23
    v_perm_b32 v16, v16, v7, s56
    v_perm_b32 v17, v17, v7, s57
    v_perm_b32 v18, v18, v7, s58
    v_perm_b32 v19, v19, v7, s59
    global_store_dwordx4 v6, v[16:19], s[26:27] sc1
    s_mov_b64 exec, -1
L_b1pubdone:
    s_sub_u32 s32, s29, 9
    s_cmp_lt_u32 s32, 2
    s_cbranch_scc0 L_rho2
    s_lshl_b32 s64, s28, 1
    s_add_u32 s32, s32, s64
    s_branch L_reducer
L_rho2:
    s_cmp_eq_u32 s32, 2
    s_cbranch_scc0 L_fin
    s_cmp_lt_u32 s28, 4
    s_cbranch_scc0 L_fin
    s_add_u32 s32, s28, 32
L_reducer:
    s_cmp_eq_u32 s30, 0
    s_cbranch_scc0 L_redh4
    v_lshrrev_b32 v6, 2, v1
    v_mul_u32_u24 v6, 2304, v6
    v_and_b32 v12, 3, v1
    v_lshlrev_b32 v12, 4, v12
    v_add_u32 v6, v6, v12
    s_lshl_b32 s64, s32, 6
    s_add_u32 s64, s64, 2097152
    v_add_u32 v6, s64, v6
    s_and_b32 s64, s2, 7
    s_mul_i32 s64, s64, 36864
    v_add_u32 v6, s64, v6
    v_and_b32 v12, 3, v1
    v_lshl_add_u32 v12, v12, 2, v3
    s_lshl_b32 s64, s32, 4
    v_add_lshl_u32 v13, s64, v12, 1
    buffer_load_ushort v40, v13, s[36:39], 0 offen
    s_sleep 8
    s_mov_b32 s66, 0
L_rh3loop:
    global_load_dwordx4 v[32:35], v6, s[26:27] sc1
    s_waitcnt vmcnt(0)
    v_perm_b32 v100, v33, v32, s62
    v_perm_b32 v101, v35, v34, s63
    v_or_b32 v100, v100, v101
    v_cmp_ne_u32 vcc, v100, v7
    s_cbranch_vccz L_rh3ok
    s_add_u32 s66, s66, 1
    s_cmp_gt_u32 s66, 20000
    s_cbranch_scc1 L_rh3ok
    s_sleep 4
    s_branch L_rh3loop
L_rh3ok:
    v_add_f32_dpp v32, v32, v32 row_ror:8 row_mask:0xf bank_mask:0xf
    v_add_f32_dpp v33, v33, v33 row_ror:8 row_mask:0xf bank_mask:0xf
    v_add_f32_dpp v34, v34, v34 row_ror:8 row_mask:0xf bank_mask:0xf
    v_add_f32_dpp v35, v35, v35 row_ror:8 row_mask:0xf bank_mask:0xf
    v_add_f32_dpp v32, v32, v32 row_ror:4 row_mask:0xf bank_mask:0xf
    v_add_f32_dpp v33, v33, v33 row_ror:4 row_mask:0xf bank_mask:0xf
    v_add_f32_dpp v34, v34, v34 row_ror:4 row_mask:0xf bank_mask:0xf
    v_add_f32_dpp v35, v35, v35 row_ror:4 row_mask:0xf bank_mask:0xf
    v_permlane16_swap_b32 v32, v33
    s_nop 0
    v_permlane16_swap_b32 v34, v35
    v_add_f32 v32, v32, v33
    v_add_f32 v34, v34, v35
    s_nop 1
    v_permlane32_swap_b32 v32, v34
    v_add_f32 v32, v32, v34
    v_cvt_pk_bf16_f32 v32, v32, v32
    v_and_b32 v32, 0xffff0000, v32
    v_lshlrev_b32 v40, 16, v40
    v_add_f32 v32, v40, v32
    v_cvt_pk_bf16_f32 v32, v32, v32
    v_and_b32 v32, 0xffff0000, v32
    v_lshlrev_b32 v12, 2, v12
    s_mov_b32 s64, 0x000f000f
    s_mov_b32 s65, 0x000f000f
    s_mov_b64 exec, s[64:65]
    ds_write_b32 v12, v32 offset:10368
    s_mov_b64 exec, -1
    s_waitcnt lgkmcnt(0)
L_redh4:
    s_barrier
    v_lshrrev_b32 v6, 2, v0
    v_mul_u32_u24 v6, 2304, v6
    v_and_b32 v12, 3, v0
    v_lshlrev_b32 v12, 4, v12
    v_add_u32 v6, v6, v12
    s_lshl_b32 s64, s32, 6
    s_add_u32 s64, s64, 655360
    v_add_u32 v6, s64, v6
    v_and_b32 v12, 3, v1
    v_lshl_add_u32 v12, v12, 2, v3
    v_lshlrev_b32 v13, 2, v12
    s_lshl_b32 s64, s30, 6
    v_add_u32 v13, s64, v13
    v_lshlrev_b32 v14, 2, v2
    v_lshl_add_u32 v14, v3, 6, v14
    s_lshl_b32 s64, s32, 4
    v_add_lshl_u32 v15, s64, v2, 1
    s_mov_b32 s52, s22
    s_mov_b32 s53, s23
    s_movk_i32 s54, 1152
    s_mov_b32 s55, 0x20000
    s_mov_b32 s70, 0x000f000f
    s_mov_b32 s71, 0x000f000f
    v_mov_b32 v42, 0
    s_sleep 40
    s_mov_b32 s66, 0
L_h4loop:
    global_load_dwordx4 v[32:35], v6, s[26:27] sc1
    s_waitcnt vmcnt(0)
    v_perm_b32 v100, v33, v32, s62
    v_perm_b32 v101, v35, v34, s63
    v_or_b32 v100, v100, v101
    v_cmp_ne_u32 vcc, v100, v7
    s_cbranch_vccz L_h4ok
    s_add_u32 s66, s66, 1
    s_cmp_gt_u32 s66, 20000
    s_cbranch_scc1 L_h4ok
    s_sleep 4
    s_branch L_h4loop
L_h4ok:
    v_add_f32_dpp v32, v32, v32 row_ror:8 row_mask:0xf bank_mask:0xf
    v_add_f32_dpp v33, v33, v33 row_ror:8 row_mask:0xf bank_mask:0xf
    v_add_f32_dpp v34, v34, v34 row_ror:8 row_mask:0xf bank_mask:0xf
    v_add_f32_dpp v35, v35, v35 row_ror:8 row_mask:0xf bank_mask:0xf
    v_add_f32_dpp v32, v32, v32 row_ror:4 row_mask:0xf bank_mask:0xf
    v_add_f32_dpp v33, v33, v33 row_ror:4 row_mask:0xf bank_mask:0xf
    v_add_f32_dpp v34, v34, v34 row_ror:4 row_mask:0xf bank_mask:0xf
    v_add_f32_dpp v35, v35, v35 row_ror:4 row_mask:0xf bank_mask:0xf
    v_permlane16_swap_b32 v32, v33
    s_nop 0
    v_permlane16_swap_b32 v34, v35
    v_add_f32 v32, v32, v33
    v_add_f32 v34, v34, v35
    s_nop 1
    v_permlane32_swap_b32 v32, v34
    v_add_f32 v32, v32, v34
    s_mov_b64 exec, s[70:71]
    ds_write_b32 v13, v32 offset:9728
    s_mov_b64 exec, -1
    s_waitcnt lgkmcnt(0)
    s_barrier
    s_cmp_eq_u32 s30, 0
    s_cbranch_scc0 L_fin
    ds_read_b32 v40, v14 offset:9728
    ds_read_b32 v41, v14 offset:9984
    s_mov_b64 exec, 0xffff
    ds_read_b32 v42, v14 offset:10240
    ds_read_b32 v43, v14 offset:10368
    s_mov_b64 exec, -1
    s_waitcnt lgkmcnt(0)
    v_add_f32 v40, v40, v41
    v_add_f32 v40, v40, v42
    v_mov_b32 v41, v40
    s_nop 1
    v_permlane16_swap_b32 v40, v41
    v_add_f32 v40, v40, v41
    v_mov_b32 v41, v40
    s_nop 1
    v_permlane32_swap_b32 v40, v41
    v_add_f32 v40, v40, v41
    v_cvt_pk_bf16_f32 v40, v40, v40
    v_and_b32 v40, 0xffff0000, v40
    v_add_f32 v40, v43, v40
    v_cvt_pk_bf16_f32 v40, v40, v40
    s_mov_b64 exec, 0xffff
    buffer_store_short v40, v15, s[52:55], 0 offen
    s_mov_b64 exec, -1
    s_cmp_eq_u32 s32, 0
    s_cbranch_scc0 L_fin
    v_mov_b32 v6, 0
    s_mov_b64 exec, 1
    global_store_dword v6, v7, s[26:27] sc1
    s_mov_b64 exec, -1
    s_branch L_fin
L_roleA:
    s_setprio 0
    s_mul_i32 s32, s28, 9
    s_add_u32 s32, s32, s29
    s_lshl_b32 s69, s30, 12
    s_add_u32 s69, s69, 13312
    v_lshlrev_b32 v4, 2, v2
    v_add_u32 v4, v4, v3
    s_lshl_b32 s34, s30, 6
    v_add_u32 v10, s34, v4
    v_lshlrev_b32 v10, 1, v10
    buffer_load_ushort v126, v10, s[36:39], 0 offen
    v_mov_b32 v12, 0x3f803f80
    v_lshlrev_b32 v10, 2, v1
    s_mov_b32 exec_lo, -1
    s_mov_b32 exec_hi, 0
    ds_write_b32 v10, v12 offset:13120
    s_mov_b64 exec, -1
    v_mul_u32_u24 v128, 2304, v3
    v_lshlrev_b32 v12, 4, v2
    v_add_u32 v128, v128, v12
    s_lshl_b32 s64, s30, 8
    s_add_u32 s64, s64, 2097152
    v_add_u32 v128, s64, v128
    s_and_b32 s64, s2, 7
    s_mul_i32 s64, s64, 36864
    v_add_u32 v128, s64, v128
    v_add_u32 v129, 9216, v128
    v_add_u32 v130, 18432, v128
    v_add_u32 v131, 27648, v128
    s_lshl_b32 s64, s30, 7
    s_add_u32 s64, s64, 6784
    v_lshlrev_b32 v132, 1, v4
    v_add_u32 v132, s64, v132
    v_lshlrev_b32 v133, 4, v3
    v_add_u32 v12, s64, v133
    v_add_u32 v133, 13120, v133
    v_cmp_eq_u32 vcc, 1, v2
    s_nop 1
    v_cndmask_b32 v133, v12, v133, vcc
    s_lshl_b32 s64, s30, 9
    s_add_u32 s64, s64, 7936
    v_lshlrev_b32 v134, 4, v3
    v_lshlrev_b32 v12, 8, v2
    v_add_u32 v134, v134, v12
    v_add_u32 v134, s64, v134
    v_lshlrev_b32 v135, 4, v2
    v_lshlrev_b32 v12, 9, v3
    v_add_u32 v135, v135, v12
    v_add_u32 v135, 7936, v135
    s_lshl_b32 s64, s30, 6
    s_add_u32 s64, s64, 12544
    v_lshlrev_b32 v136, 1, v4
    v_add_u32 v136, s64, v136
    v_lshlrev_b32 v137, 4, v3
    v_add_u32 v137, s64, v137
    s_mul_i32 s64, s32, 2304
    s_lshl_b32 s65, s30, 8
    s_add_u32 s64, s64, s65
    s_add_u32 s64, s64, 655360
    v_bfe_u32 v138, v1, 2, 2
    v_lshlrev_b32 v138, 6, v138
    v_lshlrev_b32 v12, 4, v3
    v_add_u32 v138, v138, v12
    v_add_u32 v138, s64, v138
    v_lshlrev_b32 v140, 2, v1
    v_add_u32 v140, 6656, v140
    s_lshl_b32 s64, s30, 2
    v_add_u32 v139, s64, v140
    v_lshlrev_b32 v10, 3, v3
    v_bfe_u32 v12, v1, 2, 2
    v_add_u32 v5, v10, v12
    v_lshlrev_b32 v10, 6, v5
    v_and_b32 v12, 3, v1
    v_lshlrev_b32 v12, 3, v12
    v_add_u32 v10, v10, v12
    v_add_u32 v10, s69, v10
    v_lshlrev_b32 v13, 7, v5
    v_add_u32 v13, v13, v12
    v_and_b32 v12, 1, v3
    v_lshlrev_b32 v12, 5, v12
    v_add_u32 v11, v10, v12
    v_xor_b32 v12, 32, v12
    v_add_u32 v10, v10, v12
    v_bfe_u32 v12, v1, 3, 1
    v_and_b32 v5, 1, v3
    v_lshlrev_b32 v5, 1, v5
    v_or_b32 v12, v12, v5
    v_lshlrev_b32 v12, 5, v12
    v_add_u32 v13, v13, v12
    s_add_u32 s65, s69, 73728
    v_add_u32 v13, s65, v13
    v_mov_b32 v144, 0
    v_mov_b32 v145, 0
    v_mov_b32 v146, 0
    v_mov_b32 v147, 0
    v_mov_b32 v148, 0
    v_mov_b32 v149, 0
    v_mov_b32 v150, 0
    v_mov_b32 v151, 0
    v_mov_b32 v152, 0
    v_mov_b32 v153, 0x3ae38e39
    s_mov_b32 s52, 0x00030003
    s_mov_b32 s53, 0x00030003
    s_mov_b32 s54, 0x00ff00ff
    s_mov_b32 s55, 0x00ff00ff
    s_mov_b32 s70, 0x11111111
    s_mov_b32 s71, 0x11111111
    s_cmp_ge_u32 s30, 4
    s_cbranch_scc0 L_aw0
    s_cmp_lt_u32 s30, 8
    s_cbranch_scc0 L_aw0
    s_waitcnt vmcnt(9)
    s_branch L_aw1
L_aw0:
    s_waitcnt vmcnt(0)
L_aw1:
    s_waitcnt lgkmcnt(0)
    s_barrier
    ds_read_b64_tr_b16 v[32:33], v11 offset:0
    ds_read_b64_tr_b16 v[34:35], v11 offset:256
    ds_read_b64_tr_b16 v[36:37], v10 offset:0
    ds_read_b64_tr_b16 v[38:39], v10 offset:256
    ds_read_b64_tr_b16 v[40:41], v11 offset:2048
    ds_read_b64_tr_b16 v[42:43], v11 offset:2304
    ds_read_b64_tr_b16 v[44:45], v10 offset:2048
    ds_read_b64_tr_b16 v[46:47], v10 offset:2304
    global_load_dwordx4 v[80:83], v128, s[26:27] sc1
    global_load_dwordx4 v[84:87], v129, s[26:27] sc1
    global_load_dwordx4 v[88:91], v130, s[26:27] sc1
    global_load_dwordx4 v[92:95], v131, s[26:27] sc1
    s_waitcnt lgkmcnt(0)
    ds_read_b64_tr_b16 v[48:49], v11 offset:36864
    ds_read_b64_tr_b16 v[50:51], v11 offset:37120
    ds_read_b64_tr_b16 v[52:53], v10 offset:36864
    ds_read_b64_tr_b16 v[54:55], v10 offset:37120
    ds_read_b64_tr_b16 v[56:57], v11 offset:38912
    ds_read_b64_tr_b16 v[58:59], v11 offset:39168
    ds_read_b64_tr_b16 v[60:61], v10 offset:38912
    ds_read_b64_tr_b16 v[62:63], v10 offset:39168
    s_mov_b32 s66, 0
L_h3loop:
    s_waitcnt vmcnt(0)
    v_perm_b32 v100, v81, v80, s62
    v_perm_b32 v101, v83, v82, s63
    v_or_b32 v100, v100, v101
    v_cmp_ne_u32 s[40:41], v100, v7
    v_perm_b32 v100, v85, v84, s62
    v_perm_b32 v101, v87, v86, s63
    v_or_b32 v100, v100, v101
    v_cmp_ne_u32 s[42:43], v100, v7
    v_perm_b32 v100, v89, v88, s62
    v_perm_b32 v101, v91, v90, s63
    v_or_b32 v100, v100, v101
    v_cmp_ne_u32 s[44:45], v100, v7
    v_perm_b32 v100, v93, v92, s62
    v_perm_b32 v101, v95, v94, s63
    v_or_b32 v100, v100, v101
    v_cmp_ne_u32 s[46:47], v100, v7
    s_or_b64 s[48:49], s[40:41], s[42:43]
    s_or_b64 s[50:51], s[44:45], s[46:47]
    s_or_b64 s[48:49], s[48:49], s[50:51]
    s_cbranch_scc0 L_h3ok
    s_add_u32 s66, s66, 1
    s_cmp_gt_u32 s66, 20000
    s_cbranch_scc1 L_h3ok
    s_sleep 1
    s_mov_b64 exec, s[40:41]
    s_cbranch_execz L_h3s0
    global_load_dwordx4 v[80:83], v128, s[26:27] sc1
L_h3s0:
    s_mov_b64 exec, s[42:43]
    s_cbranch_execz L_h3s1
    global_load_dwordx4 v[84:87], v129, s[26:27] sc1
L_h3s1:
    s_mov_b64 exec, s[44:45]
    s_cbranch_execz L_h3s2
    global_load_dwordx4 v[88:91], v130, s[26:27] sc1
L_h3s2:
    s_mov_b64 exec, s[46:47]
    s_cbranch_execz L_h3s3
    global_load_dwordx4 v[92:95], v131, s[26:27] sc1
L_h3s3:
    s_mov_b64 exec, -1
    s_branch L_h3loop
L_h3ok:
    v_lshlrev_b32 v126, 16, v126
    v_add_f32 v80, v80, v84
    v_add_f32 v88, v88, v92
    v_add_f32 v81, v81, v85
    v_add_f32 v89, v89, v93
    v_add_f32 v82, v82, v86
    v_add_f32 v90, v90, v94
    v_add_f32 v83, v83, v87
    v_add_f32 v91, v91, v95
    v_add_f32 v80, v80, v88
    v_add_f32 v81, v81, v89
    v_add_f32 v82, v82, v90
    v_add_f32 v83, v83, v91
    v_permlane16_swap_b32 v80, v81
    s_nop 0
    v_permlane16_swap_b32 v82, v83
    v_add_f32 v80, v80, v81
    v_add_f32 v82, v82, v83
    s_nop 1
    v_permlane32_swap_b32 v80, v82
    v_add_f32 v80, v80, v82
    v_cvt_pk_bf16_f32 v80, v80, v80
    v_and_b32 v80, 0xffff0000, v80
    v_add_f32 v80, v126, v80
    v_cvt_pk_bf16_f32 v81, v80, v80
    ds_write_b16 v132, v81
    v_and_b32 v82, 0xffff0000, v81
    v_mul_f32 v83, v82, v82
    s_nop 0
    v_add_f32_dpp v82, v82, v82 row_ror:8 row_mask:0xf bank_mask:0xf
    v_add_f32_dpp v83, v83, v83 row_ror:8 row_mask:0xf bank_mask:0xf
    s_waitcnt lgkmcnt(0)
    ds_read_b128 v[84:87], v133
    ds_read_b128 v[88:91], v133 offset:64
    v_add_f32_dpp v82, v82, v82 row_ror:4 row_mask:0xf bank_mask:0xf
    v_add_f32_dpp v83, v83, v83 row_ror:4 row_mask:0xf bank_mask:0xf
    s_nop 0
    v_add_f32_dpp v82, v82, v82 row_ror:2 row_mask:0xf bank_mask:0xf
    v_add_f32_dpp v83, v83, v83 row_ror:2 row_mask:0xf bank_mask:0xf
    s_nop 0
    v_add_f32_dpp v82, v82, v82 row_ror:1 row_mask:0xf bank_mask:0xf
    v_add_f32_dpp v83, v83, v83 row_ror:1 row_mask:0xf bank_mask:0xf
    s_nop 1
    v_permlane16_swap_b32 v82, v83
    v_add_f32 v82, v82, v83
    v_mov_b32 v83, v82
    s_nop 1
    v_permlane32_swap_b32 v82, v83
    v_add_f32 v82, v82, v83
    s_waitcnt lgkmcnt(0)
    v_mfma_f32_16x16x32_bf16 v[96:99], v[32:35], v[84:87], 0
    v_mfma_f32_16x16x32_bf16 v[100:103], v[36:39], v[84:87], 0
    v_mfma_f32_16x16x32_bf16 v[104:107], v[48:51], v[84:87], 0
    v_mfma_f32_16x16x32_bf16 v[108:111], v[52:55], v[84:87], 0
    v_mfma_f32_16x16x32_bf16 v[96:99], v[40:43], v[88:91], v[96:99]
    v_mfma_f32_16x16x32_bf16 v[100:103], v[44:47], v[88:91], v[100:103]
    v_mfma_f32_16x16x32_bf16 v[104:107], v[56:59], v[88:91], v[104:107]
    v_mfma_f32_16x16x32_bf16 v[108:111], v[60:63], v[88:91], v[108:111]
    s_mov_b64 exec, 0x10001
    ds_write_b32 v139, v82
    s_mov_b64 exec, s[52:53]
    s_nop 1
    ds_write_b128 v134, v[96:99] offset:0
    ds_write_b128 v134, v[100:103] offset:64
    ds_write_b128 v134, v[104:107] offset:128
    ds_write_b128 v134, v[108:111] offset:192
    s_mov_b64 exec, 0x01ff01ff
    s_waitcnt vmcnt(0) lgkmcnt(0)
    s_barrier
    ds_read_b32 v152, v140
    s_mov_b64 exec, -1
    ds_read_b128 v[84:87], v135
    ds_read_b128 v[88:91], v135 offset:2048
    ds_read_b128 v[100:103], v135 offset:256
    ds_read_b128 v[104:107], v135 offset:2304
    s_mov_b64 exec, 0xffff
    ds_read_b128 v[144:147], v135 offset:4096
    ds_read_b128 v[148:151], v135 offset:4352
    s_mov_b64 exec, -1
    v_xor_b32 v12, 0, v13
    ds_read_b64_tr_b16 v[64:65], v12
    ds_read_b64_tr_b16 v[66:67], v12 offset:512
    v_xor_b32 v12, 32, v13
    ds_read_b64_tr_b16 v[68:69], v12
    ds_read_b64_tr_b16 v[70:71], v12 offset:512
    v_xor_b32 v12, 64, v13
    ds_read_b64_tr_b16 v[72:73], v12
    ds_read_b64_tr_b16 v[74:75], v12 offset:512
    v_xor_b32 v12, 96, v13
    ds_read_b64_tr_b16 v[76:77], v12
    ds_read_b64_tr_b16 v[78:79], v12 offset:512
    s_waitcnt lgkmcnt(8)
    v_add_f32_dpp v152, v152, v152 row_ror:8 row_mask:0xf bank_mask:0xf
    v_add_f32 v84, v84, v88
    v_add_f32 v100, v100, v104
    v_add_f32_dpp v152, v152, v152 row_ror:4 row_mask:0xf bank_mask:0xf
    v_add_f32 v85, v85, v89
    v_add_f32 v101, v101, v105
    v_add_f32_dpp v152, v152, v152 row_ror:2 row_mask:0xf bank_mask:0xf
    v_add_f32 v86, v86, v90
    v_add_f32 v102, v102, v106
    v_add_f32_dpp v152, v152, v152 row_ror:1 row_mask:0xf bank_mask:0xf
    v_add_f32 v87, v87, v91
    v_add_f32 v103, v103, v107
    v_readlane_b32 s64, v152, 0
    v_readlane_b32 s65, v152, 16
    v_add_f32 v84, v84, v144
    v_add_f32 v100, v100, v148
    v_mul_f32 v112, s64, v153
    v_mul_f32 v113, s65, v153
    v_add_f32 v85, v85, v145
    v_add_f32 v101, v101, v149
    v_fma_f32 v113, -v112, v112, v113
    v_add_f32 v86, v86, v146
    v_add_f32 v102, v102, v150
    v_max_f32 v113, 0, v113
    v_add_f32 v87, v87, v147
    v_add_f32 v103, v103, v151
    v_cvt_pk_bf16_f32 v113, v113, v113
    v_cvt_pk_bf16_f32 v112, v112, v112
    v_permlane16_swap_b32 v84, v85
    v_and_b32 v113, 0xffff0000, v113
    v_and_b32 v112, 0xffff0000, v112
    v_permlane16_swap_b32 v86, v87
    v_add_f32 v113, 0x3727c5ac, v113
    v_permlane16_swap_b32 v100, v101
    v_cvt_pk_bf16_f32 v113, v113, v113
    v_permlane16_swap_b32 v102, v103
    v_and_b32 v113, 0xffff0000, v113
    v_add_f32 v84, v84, v85
    v_add_f32 v86, v86, v87
    v_sqrt_f32 v113, v113
    v_add_f32 v100, v100, v101
    v_add_f32 v102, v102, v103
    v_cvt_pk_bf16_f32 v113, v113, v113
    v_permlane32_swap_b32 v84, v86
    v_and_b32 v113, 0xffff0000, v113
    v_permlane32_swap_b32 v100, v102
    v_rcp_f32 v114, v113
    v_add_f32 v84, v84, v86
    v_add_f32 v100, v100, v102
    v_fma_f32 v84, -v112, v100, v84
    v_mul_f32 v85, v84, v114
    v_fma_f32 v86, -v85, v113, v84
    v_fma_f32 v85, v86, v114, v85
    v_cvt_pk_bf16_f32 v84, v85, v85
    v_and_b32 v84, 0xffff0000, v84
    s_nop 1
    v_mov_b32_dpp v85, v84 row_ror:8 row_mask:0xf bank_mask:0xf
    v_max_f32 v86, 0, v84
    v_mul_f32 v86, v86, v85
    v_cvt_pk_bf16_f32 v86, v86, v86
    s_mov_b64 exec, s[54:55]
    ds_write_b16 v136, v86
    s_mov_b64 exec, -1
    s_waitcnt lgkmcnt(0)
    ds_read_b128 v[84:87], v137
    s_waitcnt lgkmcnt(0)
    v_mfma_f32_16x16x32_bf16 v[96:99], v[64:67], v[84:87], 0
    v_mfma_f32_16x16x32_bf16 v[100:103], v[68:71], v[84:87], 0
    v_mfma_f32_16x16x32_bf16 v[104:107], v[72:75], v[84:87], 0
    v_mfma_f32_16x16x32_bf16 v[108:111], v[76:79], v[84:87], 0
    s_nop 5
    v_mov_b32_dpp v96, v100 quad_perm:[0,1,2,3] row_mask:0xf bank_mask:0x2
    v_mov_b32_dpp v97, v101 quad_perm:[0,1,2,3] row_mask:0xf bank_mask:0x2
    v_mov_b32_dpp v98, v102 quad_perm:[0,1,2,3] row_mask:0xf bank_mask:0x2
    v_mov_b32_dpp v99, v103 quad_perm:[0,1,2,3] row_mask:0xf bank_mask:0x2
    v_mov_b32_dpp v96, v104 quad_perm:[0,1,2,3] row_mask:0xf bank_mask:0x4
    v_mov_b32_dpp v97, v105 quad_perm:[0,1,2,3] row_mask:0xf bank_mask:0x4
    v_mov_b32_dpp v98, v106 quad_perm:[0,1,2,3] row_mask:0xf bank_mask:0x4
    v_mov_b32_dpp v99, v107 quad_perm:[0,1,2,3] row_mask:0xf bank_mask:0x4
    v_mov_b32_dpp v96, v108 quad_perm:[0,1,2,3] row_mask:0xf bank_mask:0x8
    v_mov_b32_dpp v97, v109 quad_perm:[0,1,2,3] row_mask:0xf bank_mask:0x8
    v_mov_b32_dpp v98, v110 quad_perm:[0,1,2,3] row_mask:0xf bank_mask:0x8
    v_mov_b32_dpp v99, v111 quad_perm:[0,1,2,3] row_mask:0xf bank_mask:0x8
    v_perm_b32 v96, v96, v7, s56
    v_perm_b32 v97, v97, v7, s57
    v_perm_b32 v98, v98, v7, s58
    v_perm_b32 v99, v99, v7, s59
    s_mov_b64 exec, s[70:71]
    global_store_dwordx4 v138, v[96:99], s[26:27] sc1
    s_mov_b64 exec, -1
L_fin:
L_end:
    s_endpgm
.section .rodata,"a"
.p2align 6
.amdhsa_kernel sequential_preLN__sliding_block_cached__glu_gated_reglu__decode_kernel
  .amdhsa_next_free_vgpr 168
  .amdhsa_next_free_sgpr 96
  .amdhsa_accum_offset 168
  .amdhsa_group_segment_fixed_size 0
  .amdhsa_kernarg_size 96
  .amdhsa_user_sgpr_count 2
  .amdhsa_user_sgpr_kernarg_segment_ptr 1
  .amdhsa_system_sgpr_workgroup_id_x 1
.end_amdhsa_kernel
```
